```python
import torch

def _softmax(x, axis=-1):
    return torch.softmax(x, dim=axis)

def _gelu(x):
    return torch.nn.functional.gelu(x, approximate='tanh')

def _silu(x):
    return torch.nn.functional.silu(x)

def _sigmoid(x):
    return torch.sigmoid(x)

def _layernorm(x, axis=-1, eps=1e-05):
    m = x.mean(dim=axis, keepdim=True)
    v = x.var(dim=axis, keepdim=True, unbiased=False)
    return (x - m) / torch.sqrt(v + eps)

def _scatter_add(tgt, idx, src, axis=0):
    return tgt.clone().index_add_(axis, idx, src)

def _segment_sum(src, seg, n):
    out = torch.zeros((n,) + src.shape[1:], dtype=src.dtype)
    return out.index_add_(0, seg, src)

def _pad(x, pw):
    flat = tuple((v for pair in reversed(pw) for v in pair))
    return torch.nn.functional.pad(x, flat)
kernel_name = 'adaLN_cond__sliding_block_cached__swiglu_ffn__decode'

def setup_inputs():

    _w = lambda a: (lambda t: t.to(torch.bfloat16) if t.is_floating_point() else t)(torch.as_tensor(a))

    def _A_setup():
        B, Sq, D = (1, 1, 448)
        Hq, Hkv, Sk, Dh = (16, 8, 16384, 256)
        assert Hq % Hkv == 0, (Hq, Hkv)
        return {'x': _w((lambda *s: torch.randn(*s, dtype=torch.bfloat16) * 0.1)(B, Sq, D)), 'k_cache': _w((lambda *s: torch.randn(*s, dtype=torch.bfloat16) * 0.8)(B, Hkv, Sk, Dh)), 'v_cache': _w((lambda *s: torch.randn(*s, dtype=torch.bfloat16) * 1.6)(B, Hkv, Sk, Dh)), 'wq': _w((lambda *s: torch.randn(*s, dtype=torch.bfloat16) * 0.8)(D, Hq * Dh) * D ** (-0.5)), 'wo': _w((lambda *s: torch.randn(*s, dtype=torch.bfloat16) * 1.6)(Hq * Dh, D) * (Hq * Dh) ** (-0.5))}
    _A_in = _A_setup()

    def _B_setup():
        B, S, D, F = (1, 1, 448, 1792)
        return {'x': _w((lambda *s: torch.randn(*s, dtype=torch.bfloat16) * 0.1)(B, S, D)), 'w_gate': _w((lambda *s: torch.randn(*s, dtype=torch.bfloat16) * 0.2)(D, F)), 'w_up': _w((lambda *s: torch.randn(*s, dtype=torch.bfloat16) * 0.2)(D, F)), 'w_down': _w((lambda *s: torch.randn(*s, dtype=torch.bfloat16) * 0.2)(F, D))}
    _B_in = _B_setup()
    return {'A_x': _A_in['x'], 'A_k_cache': _A_in['k_cache'], 'A_v_cache': _A_in['v_cache'], 'A_wq': _A_in['wq'], 'A_wo': _A_in['wo'], 'B_x': _B_in['x'], 'B_w_gate': _B_in['w_gate'], 'B_w_up': _B_in['w_up'], 'B_w_down': _B_in['w_down'], 'c': _w((lambda *s: torch.randn(*s, dtype=torch.bfloat16) * 0.8)(1, 448) * 8.0), 'w_mod': _w((lambda *s: torch.randn(*s, dtype=torch.bfloat16) * 0.8)(448, 6 * 448) * 448 ** (-0.5) * 8.0)}

def reference(A_x, A_k_cache, A_v_cache, A_wq, A_wo, B_x, B_w_gate, B_w_up, B_w_down, c, w_mod):

    def _A_ref(x, k_cache, v_cache, wq, wo):
        B, Sq, D = x.shape
        Hq, Dh = (16, 256)
        Hkv, Sk = (k_cache.shape[1], k_cache.shape[2])
        W = min(4096, max(256, Sk // 4))
        rep = Hq // Hkv
        q = (lambda x, *d: x.permute(*d))((x @ wq).reshape(B, Sq, Hq, Dh), 0, 2, 1, 3)
        k = (lambda x, n, axis: torch.repeat_interleave(x, n, dim=axis))(k_cache[:, :, Sk - W:, :], rep, axis=1)
        v = (lambda x, n, axis: torch.repeat_interleave(x, n, dim=axis))(v_cache[:, :, Sk - W:, :], rep, axis=1)
        scores = torch.einsum('bhqd,bhkd->bhqk', q, k) * Dh ** (-0.5)
        p = _softmax(scores, axis=-1)
        o = torch.einsum('bhqk,bhkd->bhqd', p, v)
        return (lambda x, *d: x.permute(*d))(o, 0, 2, 1, 3).reshape(B, Sq, Hq * Dh) @ wo

    def _B_ref(x, w_gate, w_up, w_down):
        g = _silu(x @ w_gate)
        u = x @ w_up
        return g * u @ w_down
    x = A_x
    mod = (_silu(c) @ w_mod).reshape(c.shape[0], 6, 1, -1)
    sa, ca, ga, sb, cb, gb = (mod[:, 0].clone(), mod[:, 1].clone(), mod[:, 2].clone(), mod[:, 3].clone(), mod[:, 4].clone(), mod[:, 5].clone())
    h = _layernorm(x, axis=-1) * (1 + ca) + sa
    x = x + ga * _A_ref(h, A_k_cache, A_v_cache, A_wq, A_wo)
    h = _layernorm(x, axis=-1) * (1 + cb) + sb
    x = x + gb * _B_ref(h, B_w_gate, B_w_up, B_w_down)
    return x
```

```asm
; @launch grid=(256,1,1) block=(512,1,1) lds=126976
.amdgcn_target "amdgcn-amd-amdhsa--gfx950"
.text
.globl adaLN_cond__sliding_block_cached__swiglu_ffn__decode_kernel
.p2align 8
.type adaLN_cond__sliding_block_cached__swiglu_ffn__decode_kernel,@function
adaLN_cond__sliding_block_cached__swiglu_ffn__decode_kernel:
    s_cmp_ge_u32 s2, 256
    s_cbranch_scc1 L_end
    s_load_dwordx8 s[20:27], s[0:1], 64
    s_load_dwordx16 s[4:19], s[0:1], 0
    s_load_dwordx4 s[28:31], s[0:1], 96
    v_readfirstlane_b32 s3, v0
    v_and_b32 v0, 63, v0
    s_bfm_b32 s47, 1, 17
    s_bfm_b32 s51, 1, 17
    s_lshr_b32 s3, s3, 6

    s_cmp_lt_u32 s2, 32
    s_cbranch_scc0 L_att

    s_cmp_ge_u32 s2, 28
    s_cbranch_scc1 L_end
    s_and_b32 s57, s2, 1
    s_mulk_i32 s57, 224
    s_lshr_b32 s56, s2, 1
    s_cmp_eq_u32 s3, 7
    s_cbranch_scc1 L_sv7
    s_lshl_b32 s58, s3, 5
    s_add_u32 s58, s58, s57
    s_mul_i32 s65, s58, 5376
    s_lshl_b32 s59, s56, 7
    s_add_u32 s65, s65, s59
    s_lshl_b32 s58, s58, 1
    v_and_b32 v2, 3, v0
    v_lshlrev_b32 v2, 1, v2
    v_and_or_b32 v2, v0, 56, v2
    v_lshrrev_b32 v1, 3, v0
    v_and_b32 v3, 7, v0
    v_lshlrev_b32 v3, 4, v3
    s_movk_i32 s59, 21504
    v_mad_u32_u24 v3, v1, s59, v3
    s_movk_i32 s46, 896
    s_mov_b32 s50, 2408448
    s_waitcnt lgkmcnt(0)

    s_mov_b64 s[44:45], s[22:23]
    s_mov_b64 s[48:49], s[24:25]

    buffer_load_ushort v6, v2, s[44:47], s58 offen
    buffer_load_dwordx4 v[32:35], v3, s[48:51], s65 offen nt
    s_addk_i32 s65, 5376
    buffer_load_dwordx4 v[36:39], v3, s[48:51], s65 offen nt
    s_addk_i32 s65, 5376
    buffer_load_dwordx4 v[40:43], v3, s[48:51], s65 offen nt
    s_addk_i32 s65, 5376
    buffer_load_dwordx4 v[44:47], v3, s[48:51], s65 offen nt
    s_branch L_svc2
L_att:
    s_and_b32 s32, s2, 7
    s_lshr_b32 s33, s2, 3
    s_sub_u32 s33, s33, 4
    s_cmp_lt_u32 s33, 8
    s_cbranch_scc0 L_w

    s_mul_i32 s58, s3, 56
    s_lshl_b32 s59, s58, 13
    s_lshl_b32 s60, s32, 10
    s_add_u32 s59, s59, s60
    s_lshl_b32 s60, s33, 7
    s_add_u32 s59, s59, s60
    s_movk_i32 s46, 896
    s_mov_b32 s50, 3670016
    v_lshrrev_b32 v3, 3, v0
    v_mul_u32_u24 v3, 7, v3
    v_and_b32 v4, 7, v0
    v_lshlrev_b32 v5, 4, v4
    v_lshl_or_b32 v5, v3, 13, v5
    v_min_u32 v4, 6, v4
    v_add3_u32 v4, v4, v3, s58
    v_lshlrev_b32 v6, 1, v4
    v_lshlrev_b32 v8, 4, v0
    s_waitcnt lgkmcnt(0)

    s_mov_b64 s[44:45], s[4:5]
    s_mov_b64 s[48:49], s[10:11]
    buffer_load_dwordx4 v[12:15], v8, s[44:47], 0 offen
    buffer_load_ushort v9, v6, s[44:47], 0 offen

    buffer_load_dwordx4 v[32:35], v5, s[48:51], s59 offen nt
    s_addk_i32 s59, 8192
    buffer_load_dwordx4 v[36:39], v5, s[48:51], s59 offen nt
    s_addk_i32 s59, 8192
    buffer_load_dwordx4 v[40:43], v5, s[48:51], s59 offen nt
    s_addk_i32 s59, 8192
    buffer_load_dwordx4 v[44:47], v5, s[48:51], s59 offen nt
    s_addk_i32 s59, 8192
    buffer_load_dwordx4 v[48:51], v5, s[48:51], s59 offen nt
    s_addk_i32 s59, 8192
    buffer_load_dwordx4 v[52:55], v5, s[48:51], s59 offen nt
    s_addk_i32 s59, 8192
    buffer_load_dwordx4 v[56:59], v5, s[48:51], s59 offen nt
    s_branch L_q2
L_w:
    s_cmp_lt_u32 s3, 4
    s_cbranch_scc0 L_streamW

    s_cmp_lt_u32 s33, 12
    s_cbranch_scc0 L_pc1x
    s_getpc_b64 s[60:61]
L_pc1:
    s_sub_u32 s60, s60, L_pc1-adaLN_cond__sliding_block_cached__swiglu_ffn__decode_kernel
    s_subb_u32 s61, s61, 0
    s_mul_i32 s56, s3, 5120
    v_lshl_add_u32 v4, v0, 7, s56
    v_min_u32 v4, L_code_end-adaLN_cond__sliding_block_cached__swiglu_ffn__decode_kernel-4, v4
    s_mov_b32 exec_hi, 0xff
    global_load_dword v200, v4, s[60:61]
    s_mov_b32 exec_hi, -1
L_pc1x:

    s_setprio 3
    s_lshl_b32 s56, s33, 2
    s_add_u32 s56, s56, s3
    s_sub_u32 s56, s56, 32
    s_mul_i32 s56, s56, 48
    s_add_u32 s56, s56, s32
    s_lshl_b32 s56, s56, 10
    s_mov_b32 s50, 3670016
    v_lshrrev_b32 v3, 3, v0
    v_lshlrev_b32 v3, 6, v3
    v_and_or_b32 v3, v0, 7, v3
    v_lshl_add_u32 v3, v3, 7, s56
    s_mov_b32 exec_hi, 0xffff
    s_waitcnt lgkmcnt(0)
    s_mov_b64 s[48:49], s[10:11]
    buffer_load_dword v201, v3, s[48:51], 0 offen nt
    s_mov_b32 exec_hi, -1

    s_branch L_front
L_streamW:
    s_setprio 1
    s_sub_u32 s56, s3, 4
    s_lshl_b32 s57, s33, 2
    s_add_u32 s57, s57, s56

    s_cmp_lt_u32 s33, 14
    s_cselect_b32 s61, 44, 44
    s_cselect_b32 s59, 0, 0
    s_mul_i32 s58, s57, s61
    s_add_u32 s58, s58, s59
    s_add_u32 s58, s58, 11456

    s_lshl_b32 s58, s58, 9
    s_lshl_b32 s60, s32, 23

    s_add_u32 s62, s58, s60
    s_lshl_b32 s60, s61, 9
    s_add_u32 s46, s62, s60

    s_mov_b32 s50, s46
    s_add_u32 s63, s62, 4096
    s_add_u32 s64, s62, 8192
    s_add_u32 s65, s62, 12288
    s_add_u32 s66, s62, 16384
    s_add_u32 s67, s62, 20480
    s_mul_i32 s68, s56, 24576
    s_add_u32 s68, s68, 12544
    s_mov_b32 m0, s68
    v_and_b32 v1, 31, v0
    v_lshrrev_b32 v10, 5, v0
    v_lshlrev_b32 v11, 2, v10
    v_xor_b32 v1, v1, v11
    v_lshlrev_b32 v1, 4, v1
    v_lshl_or_b32 v2, v10, 9, v1
    v_xor_b32 v3, 0x80, v2
    v_xor_b32 v4, 16, v2
    v_xor_b32 v5, 0x90, v2
    v_xor_b32 v6, 32, v2
    v_xor_b32 v7, 0xa0, v2
    v_xor_b32 v8, 48, v2
    v_xor_b32 v9, 0xb0, v2

    v_lshrrev_b32 v20, 4, v0
    v_and_b32 v21, 15, v0
    v_lshlrev_b32 v10, 9, v20
    v_lshl_or_b32 v10, v21, 4, v10
    s_waitcnt lgkmcnt(0)
    s_mov_b64 s[44:45], s[6:7]
    s_mov_b64 s[48:49], s[8:9]
    buffer_load_dwordx4 v2, s[44:47], s62 offen offset:0 nt lds
    s_load_dword s34, s[30:31], 0
    buffer_load_dwordx4 v3, s[44:47], s62 offen offset:1024 nt lds
    buffer_load_dwordx4 v4, s[44:47], s62 offen offset:2048 nt lds
    buffer_load_dwordx4 v5, s[44:47], s62 offen offset:3072 nt lds
    s_add_u32 m0, s68, 4096
    s_nop 0
    buffer_load_dwordx4 v6, s[44:47], s63 offen offset:0 nt lds
    buffer_load_dwordx4 v7, s[44:47], s63 offen offset:1024 nt lds
    buffer_load_dwordx4 v8, s[44:47], s63 offen offset:2048 nt lds
    buffer_load_dwordx4 v9, s[44:47], s63 offen offset:3072 nt lds
    s_barrier
    s_add_u32 m0, s68, 8192
    s_waitcnt vmcnt(7)
    buffer_load_dwordx4 v2, s[44:47], s64 offen offset:0 nt lds
    s_waitcnt vmcnt(7)
    buffer_load_dwordx4 v3, s[44:47], s64 offen offset:1024 nt lds
    s_waitcnt vmcnt(7)
    buffer_load_dwordx4 v4, s[44:47], s64 offen offset:2048 nt lds
    s_waitcnt vmcnt(7)
    buffer_load_dwordx4 v5, s[44:47], s64 offen offset:3072 nt lds
    s_add_u32 m0, s68, 12288
    s_waitcnt vmcnt(7)
    buffer_load_dwordx4 v6, s[44:47], s65 offen offset:0 nt lds
    s_waitcnt vmcnt(7)
    buffer_load_dwordx4 v7, s[44:47], s65 offen offset:1024 nt lds
    s_waitcnt vmcnt(7)
    buffer_load_dwordx4 v8, s[44:47], s65 offen offset:2048 nt lds
    s_waitcnt vmcnt(7)
    buffer_load_dwordx4 v9, s[44:47], s65 offen offset:3072 nt lds
    s_add_u32 m0, s68, 16384
    s_waitcnt vmcnt(7)
    buffer_load_dwordx4 v2, s[44:47], s66 offen offset:0 nt lds
    s_waitcnt vmcnt(7)
    buffer_load_dwordx4 v3, s[44:47], s66 offen offset:1024 nt lds
    s_waitcnt vmcnt(7)
    buffer_load_dwordx4 v4, s[44:47], s66 offen offset:2048 nt lds
    s_waitcnt vmcnt(7)
    buffer_load_dwordx4 v5, s[44:47], s66 offen offset:3072 nt lds
    s_add_u32 m0, s68, 20480
    s_waitcnt vmcnt(7)
    buffer_load_dwordx4 v6, s[44:47], s67 offen offset:0 nt lds
    s_waitcnt vmcnt(7)
    buffer_load_dwordx4 v7, s[44:47], s67 offen offset:1024 nt lds
    s_waitcnt vmcnt(7)
    buffer_load_dwordx4 v[160:163], v10, s[48:51], s62 offen offset:0 nt
    v_lshrrev_b32 v22, 2, v21
    v_and_b32 v23, 3, v21
    v_lshl_add_u32 v22, v23, 2, v22
    v_xor_b32 v23, v20, v21
    v_lshlrev_b32 v23, 4, v23
    v_lshl_add_u32 v22, v22, 9, v23
    v_add_u32 v11, s68, v22
    v_xor_b32 v12, 64, v11
    v_xor_b32 v13, 0x80, v11
    v_xor_b32 v14, 0xc0, v11
    v_bfe_u32 v22, v0, 3, 1
    v_lshlrev_b32 v23, 4, v20
    v_lshl_add_u32 v15, v22, 9, v23
    v_lshlrev_b32 v1, 4, v22
    s_lshl_b32 s57, s56, 2
    v_add_u32 v3, s57, v1
    v_sub_u32 v2, s61, v20

    v_lshrrev_b32 v22, 5, v0
    v_lshlrev_b32 v22, 10, v22
    v_lshl_or_b32 v22, v21, 5, v22
    v_bfe_u32 v23, v0, 4, 1
    v_lshl_or_b32 v22, v23, 4, v22
    s_lshl_b32 s57, s56, 11
    v_add_u32 v4, s57, v22
    s_lshl_b32 s57, s56, 9
    v_and_b32 v5, 31, v0
    v_lshlrev_b32 v5, 4, v5
    v_add_u32 v6, s57, v5
    s_lshl_b32 s57, s32, 1
    s_lshr_b32 s58, s56, 1
    s_add_u32 s57, s57, s58
    s_lshl_b32 s57, s57, 5
    s_add_u32 s57, s57, s33
    s_lshl_b32 s57, s57, 10
    s_and_b32 s58, s56, 1
    s_lshl_b32 s58, s58, 9
    s_add_u32 s57, s57, s58
    s_add_u32 s68, s57, 262144
    s_mov_b64 s[40:41], s[30:31]

    s_mov_b32 s42, 1048576
    s_mov_b32 s43, 0x20000

    s_mov_b64 s[56:57], 0xffff
    v_lshlrev_b32 v22, 4, v0
    v_lshlrev_b64 v[16:17], v22, s[56:57]
    v_bfe_i32 v22, v0, 2, 1
    v_and_b32 v18, v16, v22
    v_and_b32 v19, v17, v22
    v_xor_b32 v16, v16, v18
    v_xor_b32 v17, v17, v19

    s_mov_b32 s60, 0xffff0000
    s_mov_b32 s61, 1035512379
    v_mov_b32 v2, 0xff7f0000
    v_mov_b32 v7, 0xffffff00
    v_mov_b32 v8, 0
    s_waitcnt lgkmcnt(0)

    s_add_u32 s34, s34, 2654435761
    s_and_b32 s36, s34, 0xff
    s_bfe_u32 s37, s34, 0x80008
    s_bfe_u32 s38, s34, 0x80010
    s_lshr_b32 s39, s34, 24

    s_waitcnt vmcnt(7)
    buffer_load_dwordx4 v[164:167], v10, s[48:51], s62 offen offset:256 nt
    s_waitcnt vmcnt(7)
    buffer_load_dwordx4 v[168:171], v10, s[48:51], s62 offen offset:2048 nt
    s_waitcnt vmcnt(7)
    buffer_load_dwordx4 v[172:175], v10, s[48:51], s62 offen offset:2304 nt
    s_waitcnt vmcnt(7)
    buffer_load_dwordx4 v[176:179], v10, s[48:51], s63 offen offset:0 nt
    s_waitcnt vmcnt(7)
    buffer_load_dwordx4 v[180:183], v10, s[48:51], s63 offen offset:256 nt
    s_waitcnt vmcnt(7)
    buffer_load_dwordx4 v[184:187], v10, s[48:51], s63 offen offset:2048 nt
    s_waitcnt vmcnt(7)
    buffer_load_dwordx4 v[188:191], v10, s[48:51], s63 offen offset:2304 nt
    ds_read_b128 v[64:67], v11 offset:0
    ds_read_b128 v[68:71], v11 offset:8192
    ds_read_b128 v[72:75], v11 offset:16384
    ds_read_b128 v[76:79], v12 offset:0
    ds_read_b128 v[80:83], v12 offset:8192
    ds_read_b128 v[84:87], v12 offset:16384
    ds_read_b128 v[88:91], v13 offset:0
    ds_read_b128 v[92:95], v13 offset:8192
    s_waitcnt vmcnt(7) lgkmcnt(0)
    buffer_load_dwordx4 v[192:195], v10, s[48:51], s64 offen offset:0 nt
    ds_read_b128 v[96:99], v13 offset:16384
    ds_read_b128 v[100:103], v14 offset:0
    ds_read_b128 v[104:107], v14 offset:8192
    ds_read_b128 v[108:111], v14 offset:16384
    ds_read_b128 v[112:115], v11 offset:256
    ds_read_b128 v[116:119], v11 offset:8448
    ds_read_b128 v[120:123], v11 offset:16640
    ds_read_b128 v[124:127], v12 offset:256
    s_waitcnt vmcnt(7) lgkmcnt(0)
    buffer_load_dwordx4 v[196:199], v10, s[48:51], s64 offen offset:256 nt
    ds_read_b128 v[128:131], v12 offset:8448
    ds_read_b128 v[132:135], v12 offset:16640
    ds_read_b128 v[136:139], v13 offset:256
    ds_read_b128 v[140:143], v13 offset:8448
    ds_read_b128 v[144:147], v13 offset:16640
    ds_read_b128 v[148:151], v14 offset:256
    ds_read_b128 v[152:155], v14 offset:8448
    ds_read_b128 v[156:159], v14 offset:16640
    ds_read_b32 v9, v8 offset:1188
    s_waitcnt lgkmcnt(0)
    v_cmp_ne_u32 vcc, -1, v9
    s_cbranch_vccnz L_stW9

    s_waitcnt vmcnt(7) lgkmcnt(0)
    buffer_load_dwordx4 v[200:203], v10, s[48:51], s64 offen offset:2048 nt
    ds_read_b32 v9, v8 offset:1188
    s_waitcnt lgkmcnt(0)
    v_cmp_ne_u32 vcc, -1, v9
    s_cbranch_vccnz L_stW10

    s_waitcnt vmcnt(7) lgkmcnt(0)
    buffer_load_dwordx4 v[204:207], v10, s[48:51], s64 offen offset:2304 nt
    ds_read_b32 v9, v8 offset:1188
    s_waitcnt lgkmcnt(0)
    v_cmp_ne_u32 vcc, -1, v9
    s_cbranch_vccnz L_stW11

    s_waitcnt vmcnt(7) lgkmcnt(0)
    buffer_load_dwordx4 v[208:211], v10, s[48:51], s65 offen offset:0 nt
    ds_read_b32 v9, v8 offset:1188
    s_waitcnt lgkmcnt(0)
    v_cmp_ne_u32 vcc, -1, v9
    s_cbranch_vccnz L_stW12

    s_waitcnt vmcnt(7) lgkmcnt(0)
    buffer_load_dwordx4 v[212:215], v10, s[48:51], s65 offen offset:256 nt
    ds_read_b32 v9, v8 offset:1188
    s_waitcnt lgkmcnt(0)
    v_cmp_ne_u32 vcc, -1, v9
    s_cbranch_vccnz L_stW13

    s_waitcnt vmcnt(7) lgkmcnt(0)
    buffer_load_dwordx4 v[216:219], v10, s[48:51], s65 offen offset:2048 nt
    ds_read_b32 v9, v8 offset:1188
    s_waitcnt lgkmcnt(0)
    v_cmp_ne_u32 vcc, -1, v9
    s_cbranch_vccnz L_stW14

    s_waitcnt vmcnt(7) lgkmcnt(0)
    buffer_load_dwordx4 v[220:223], v10, s[48:51], s65 offen offset:2304 nt
    ds_read_b32 v9, v8 offset:1188
    s_waitcnt lgkmcnt(0)
    v_cmp_ne_u32 vcc, -1, v9
    s_cbranch_vccnz L_stW15

    s_waitcnt vmcnt(7) lgkmcnt(0)
    buffer_load_dwordx4 v[224:227], v10, s[48:51], s66 offen offset:0 nt
    ds_read_b32 v9, v8 offset:1188
    s_waitcnt lgkmcnt(0)
    v_cmp_ne_u32 vcc, -1, v9
    s_cbranch_vccnz L_stW16

    s_waitcnt vmcnt(7) lgkmcnt(0)
    buffer_load_dwordx4 v[228:231], v10, s[48:51], s66 offen offset:256 nt
    ds_read_b32 v9, v8 offset:1188
    s_waitcnt lgkmcnt(0)
    v_cmp_ne_u32 vcc, -1, v9
    s_cbranch_vccnz L_stW17

    s_waitcnt vmcnt(7) lgkmcnt(0)
    buffer_load_dwordx4 v[232:235], v10, s[48:51], s66 offen offset:2048 nt
    ds_read_b32 v9, v8 offset:1188
    s_waitcnt lgkmcnt(0)
    v_cmp_ne_u32 vcc, -1, v9
    s_cbranch_vccnz L_stW18

    s_waitcnt vmcnt(7) lgkmcnt(0)
    buffer_load_dwordx4 v[236:239], v10, s[48:51], s66 offen offset:2304 nt
    ds_read_b32 v9, v8 offset:1188
    s_waitcnt lgkmcnt(0)
    v_cmp_ne_u32 vcc, -1, v9
    s_cbranch_vccnz L_stW19

    s_waitcnt vmcnt(7) lgkmcnt(0)
    buffer_load_dwordx4 v[240:243], v10, s[48:51], s67 offen offset:0 nt
    ds_read_b32 v9, v8 offset:1188
    s_waitcnt lgkmcnt(0)
    v_cmp_ne_u32 vcc, -1, v9
    s_cbranch_vccnz L_stW20

    s_waitcnt vmcnt(7) lgkmcnt(0)
    buffer_load_dwordx4 v[244:247], v10, s[48:51], s67 offen offset:256 nt
    ds_write_b32 v3, v8 offset:1088
    s_movk_i32 s35, 20000
L_sq2:
    ds_read_b32 v9, v8 offset:1188
    s_waitcnt lgkmcnt(0)
    v_cmp_eq_u32 vcc, -1, v9

    s_cbranch_vccz L_sq2_ok
    s_sub_u32 s35, s35, 1
    s_cbranch_scc0 L_sq2
L_sq2_ok:

    s_call_b64 s[96:97], L_qkW
L_qkrW:
    s_branch L_qkdW

L_stW9:
    buffer_load_dwordx4 v[200:203], v10, s[48:51], s64 offen offset:2048 nt
    buffer_load_dwordx4 v[204:207], v10, s[48:51], s64 offen offset:2304 nt
    buffer_load_dwordx4 v[208:211], v10, s[48:51], s65 offen offset:0 nt
    buffer_load_dwordx4 v[212:215], v10, s[48:51], s65 offen offset:256 nt
    s_call_b64 s[96:97], L_qkW
L_srW9:
    s_branch L_cbW14

L_stW10:
    buffer_load_dwordx4 v[204:207], v10, s[48:51], s64 offen offset:2304 nt
    buffer_load_dwordx4 v[208:211], v10, s[48:51], s65 offen offset:0 nt
    buffer_load_dwordx4 v[212:215], v10, s[48:51], s65 offen offset:256 nt
    buffer_load_dwordx4 v[216:219], v10, s[48:51], s65 offen offset:2048 nt
    s_call_b64 s[96:97], L_qkW
L_srW10:
    s_branch L_cbW15

L_stW11:
    buffer_load_dwordx4 v[208:211], v10, s[48:51], s65 offen offset:0 nt
    buffer_load_dwordx4 v[212:215], v10, s[48:51], s65 offen offset:256 nt
    buffer_load_dwordx4 v[216:219], v10, s[48:51], s65 offen offset:2048 nt
    buffer_load_dwordx4 v[220:223], v10, s[48:51], s65 offen offset:2304 nt
    s_call_b64 s[96:97], L_qkW
L_srW11:
    s_branch L_cbW16

L_stW12:
    buffer_load_dwordx4 v[212:215], v10, s[48:51], s65 offen offset:256 nt
    buffer_load_dwordx4 v[216:219], v10, s[48:51], s65 offen offset:2048 nt
    buffer_load_dwordx4 v[220:223], v10, s[48:51], s65 offen offset:2304 nt
    buffer_load_dwordx4 v[224:227], v10, s[48:51], s66 offen offset:0 nt
    s_call_b64 s[96:97], L_qkW
L_srW12:
    s_branch L_cbW17

L_stW13:
    buffer_load_dwordx4 v[216:219], v10, s[48:51], s65 offen offset:2048 nt
    buffer_load_dwordx4 v[220:223], v10, s[48:51], s65 offen offset:2304 nt
    buffer_load_dwordx4 v[224:227], v10, s[48:51], s66 offen offset:0 nt
    buffer_load_dwordx4 v[228:231], v10, s[48:51], s66 offen offset:256 nt
    s_call_b64 s[96:97], L_qkW
L_srW13:
    s_branch L_cbW18

L_stW14:
    buffer_load_dwordx4 v[220:223], v10, s[48:51], s65 offen offset:2304 nt
    buffer_load_dwordx4 v[224:227], v10, s[48:51], s66 offen offset:0 nt
    buffer_load_dwordx4 v[228:231], v10, s[48:51], s66 offen offset:256 nt
    buffer_load_dwordx4 v[232:235], v10, s[48:51], s66 offen offset:2048 nt
    s_call_b64 s[96:97], L_qkW
L_srW14:
    s_branch L_cbW19

L_stW15:
    buffer_load_dwordx4 v[224:227], v10, s[48:51], s66 offen offset:0 nt
    buffer_load_dwordx4 v[228:231], v10, s[48:51], s66 offen offset:256 nt
    buffer_load_dwordx4 v[232:235], v10, s[48:51], s66 offen offset:2048 nt
    buffer_load_dwordx4 v[236:239], v10, s[48:51], s66 offen offset:2304 nt
    s_call_b64 s[96:97], L_qkW
L_srW15:
    s_branch L_cbW20

L_stW16:
    buffer_load_dwordx4 v[228:231], v10, s[48:51], s66 offen offset:256 nt
    buffer_load_dwordx4 v[232:235], v10, s[48:51], s66 offen offset:2048 nt
    buffer_load_dwordx4 v[236:239], v10, s[48:51], s66 offen offset:2304 nt
    buffer_load_dwordx4 v[240:243], v10, s[48:51], s67 offen offset:0 nt
    s_call_b64 s[96:97], L_qkW
L_srW16:
    s_branch L_cbW21

L_stW17:
    buffer_load_dwordx4 v[232:235], v10, s[48:51], s66 offen offset:2048 nt
    buffer_load_dwordx4 v[236:239], v10, s[48:51], s66 offen offset:2304 nt
    buffer_load_dwordx4 v[240:243], v10, s[48:51], s67 offen offset:0 nt
    buffer_load_dwordx4 v[244:247], v10, s[48:51], s67 offen offset:256 nt
    ds_write_b32 v3, v8 offset:1088
    s_call_b64 s[96:97], L_qkW
L_srW17:
    s_branch L_cbW22

L_stW18:
    buffer_load_dwordx4 v[236:239], v10, s[48:51], s66 offen offset:2304 nt
    buffer_load_dwordx4 v[240:243], v10, s[48:51], s67 offen offset:0 nt
    buffer_load_dwordx4 v[244:247], v10, s[48:51], s67 offen offset:256 nt
    ds_write_b32 v3, v8 offset:1088
    s_call_b64 s[96:97], L_qkW
L_srW18:
    s_branch L_cbW22

L_stW19:
    buffer_load_dwordx4 v[240:243], v10, s[48:51], s67 offen offset:0 nt
    buffer_load_dwordx4 v[244:247], v10, s[48:51], s67 offen offset:256 nt
    ds_write_b32 v3, v8 offset:1088
    s_call_b64 s[96:97], L_qkW
L_srW19:
    s_branch L_cbW22

L_stW20:
    buffer_load_dwordx4 v[244:247], v10, s[48:51], s67 offen offset:256 nt
    ds_write_b32 v3, v8 offset:1088
    s_call_b64 s[96:97], L_qkW
L_srW20:
    s_branch L_cbW22

L_cbW14:
    s_waitcnt vmcnt(7)
    buffer_load_dwordx4 v[216:219], v10, s[48:51], s65 offen offset:2048 nt
L_cbW15:
    s_waitcnt vmcnt(7)
    buffer_load_dwordx4 v[220:223], v10, s[48:51], s65 offen offset:2304 nt
L_cbW16:
    s_waitcnt vmcnt(7)
    buffer_load_dwordx4 v[224:227], v10, s[48:51], s66 offen offset:0 nt
L_cbW17:
    s_waitcnt vmcnt(7)
    buffer_load_dwordx4 v[228:231], v10, s[48:51], s66 offen offset:256 nt
L_cbW18:
    s_waitcnt vmcnt(7)
    buffer_load_dwordx4 v[232:235], v10, s[48:51], s66 offen offset:2048 nt
L_cbW19:
    s_waitcnt vmcnt(7)
    buffer_load_dwordx4 v[236:239], v10, s[48:51], s66 offen offset:2304 nt
L_cbW20:
    s_waitcnt vmcnt(7)
    buffer_load_dwordx4 v[240:243], v10, s[48:51], s67 offen offset:0 nt
L_cbW21:
    s_waitcnt vmcnt(7)
    buffer_load_dwordx4 v[244:247], v10, s[48:51], s67 offen offset:256 nt
    ds_write_b32 v3, v8 offset:1088
L_cbW22:
L_qkdW:
    s_setprio 2

    s_movk_i32 s35, 20000
L_sm3:
    ds_read_b128 v[44:47], v1 offset:1024
    ds_read_b32 v49, v15 offset:1024
    s_waitcnt lgkmcnt(1)
    v_or3_b32 v48, v44, v45, v46
    v_max3_f32 v44, v44, v45, v46
    v_bitop3_b32 v48, v48, v47, s60 bitop3:0x54
    v_max_f32 v44, v44, v47
    v_cmp_ne_u32 vcc, 0, v48

    s_cbranch_vccz L_sm3_ok
    s_sub_u32 s35, s35, 1
    s_cbranch_scc0 L_sm3
L_sm3_ok:

    s_waitcnt lgkmcnt(0)
    v_sub_f32 v44, v49, v44
    v_mul_f32 v44, s61, v44
    v_exp_f32 v44, v44

    v_and_b32 v64, v120, v16
    v_and_b32 v65, v120, v17
    v_and_b32 v66, v120, v18
    v_and_b32 v67, v120, v19
    v_and_b32 v68, v121, v16
    v_and_b32 v69, v121, v17
    v_and_b32 v70, v121, v18
    v_and_b32 v71, v121, v19
    s_waitcnt vmcnt(21)
    v_mfma_f32_16x16x32_bf16 v[112:115], v[64:67], v[160:163], 0
    s_waitcnt vmcnt(20)
    v_mfma_f32_16x16x32_bf16 v[116:119], v[64:67], v[164:167], 0
    v_and_b32 v72, v122, v16
    v_and_b32 v73, v122, v17
    v_and_b32 v74, v122, v18
    v_and_b32 v75, v122, v19
    s_waitcnt vmcnt(19)
    v_mfma_f32_16x16x32_bf16 v[112:115], v[68:71], v[168:171], v[112:115]
    s_waitcnt vmcnt(18)
    v_mfma_f32_16x16x32_bf16 v[116:119], v[68:71], v[172:175], v[116:119]
    v_and_b32 v76, v123, v16
    v_and_b32 v77, v123, v17
    v_and_b32 v78, v123, v18
    v_and_b32 v79, v123, v19
    s_waitcnt vmcnt(17)
    v_mfma_f32_16x16x32_bf16 v[112:115], v[72:75], v[176:179], v[112:115]
    s_waitcnt vmcnt(16)
    v_mfma_f32_16x16x32_bf16 v[116:119], v[72:75], v[180:183], v[116:119]
    v_and_b32 v80, v124, v16
    v_and_b32 v81, v124, v17
    v_and_b32 v82, v124, v18
    v_and_b32 v83, v124, v19
    s_waitcnt vmcnt(15)
    v_mfma_f32_16x16x32_bf16 v[112:115], v[76:79], v[184:187], v[112:115]
    s_waitcnt vmcnt(14)
    v_mfma_f32_16x16x32_bf16 v[116:119], v[76:79], v[188:191], v[116:119]
    v_and_b32 v84, v125, v16
    v_and_b32 v85, v125, v17
    v_and_b32 v86, v125, v18
    v_and_b32 v87, v125, v19
    s_waitcnt vmcnt(13)
    v_mfma_f32_16x16x32_bf16 v[112:115], v[80:83], v[192:195], v[112:115]
    s_waitcnt vmcnt(12)
    v_mfma_f32_16x16x32_bf16 v[116:119], v[80:83], v[196:199], v[116:119]
    v_and_b32 v88, v126, v16
    v_and_b32 v89, v126, v17
    v_and_b32 v90, v126, v18
    v_and_b32 v91, v126, v19
    s_waitcnt vmcnt(11)
    v_mfma_f32_16x16x32_bf16 v[112:115], v[84:87], v[200:203], v[112:115]
    s_waitcnt vmcnt(10)
    v_mfma_f32_16x16x32_bf16 v[116:119], v[84:87], v[204:207], v[116:119]
    v_and_b32 v92, v127, v16
    v_and_b32 v93, v127, v17
    v_and_b32 v94, v127, v18
    v_and_b32 v95, v127, v19
    s_waitcnt vmcnt(9)
    v_mfma_f32_16x16x32_bf16 v[112:115], v[88:91], v[208:211], v[112:115]
    s_waitcnt vmcnt(8)
    v_mfma_f32_16x16x32_bf16 v[116:119], v[88:91], v[212:215], v[116:119]
    v_and_b32 v96, v128, v16
    v_and_b32 v97, v128, v17
    v_and_b32 v98, v128, v18
    v_and_b32 v99, v128, v19
    s_waitcnt vmcnt(7)
    v_mfma_f32_16x16x32_bf16 v[112:115], v[92:95], v[216:219], v[112:115]
    s_waitcnt vmcnt(6)
    v_mfma_f32_16x16x32_bf16 v[116:119], v[92:95], v[220:223], v[116:119]
    v_and_b32 v100, v129, v16
    v_and_b32 v101, v129, v17
    v_and_b32 v102, v129, v18
    v_and_b32 v103, v129, v19
    s_waitcnt vmcnt(5)
    v_mfma_f32_16x16x32_bf16 v[112:115], v[96:99], v[224:227], v[112:115]
    s_waitcnt vmcnt(4)
    v_mfma_f32_16x16x32_bf16 v[116:119], v[96:99], v[228:231], v[116:119]
    v_and_b32 v104, v130, v16
    v_and_b32 v105, v130, v17
    v_and_b32 v106, v130, v18
    v_and_b32 v107, v130, v19
    s_waitcnt vmcnt(3)
    v_mfma_f32_16x16x32_bf16 v[112:115], v[100:103], v[232:235], v[112:115]
    s_waitcnt vmcnt(2)
    v_mfma_f32_16x16x32_bf16 v[116:119], v[100:103], v[236:239], v[116:119]
    s_waitcnt vmcnt(1)
    v_mfma_f32_16x16x32_bf16 v[112:115], v[104:107], v[240:243], v[112:115]
    s_waitcnt vmcnt(0)
    v_mfma_f32_16x16x32_bf16 v[116:119], v[104:107], v[244:247], v[116:119]
    s_nop 5
    v_pk_mul_f32 v[112:113], v[112:113], v[44:45] op_sel_hi:[1,0]
    v_pk_mul_f32 v[114:115], v[114:115], v[44:45] op_sel_hi:[1,0]
    v_pk_mul_f32 v[116:117], v[116:117], v[44:45] op_sel_hi:[1,0]
    v_pk_mul_f32 v[118:119], v[118:119], v[44:45] op_sel_hi:[1,0]
    ds_write_b128 v4, v[112:115] offset:4352
    ds_write_b128 v4, v[116:119] offset:4864
    ds_write_b32 v3, v8 offset:1120
    s_mov_b32 exec_hi, 0

    s_movk_i32 s35, 20000
L_so4:
    ds_read_b128 v[36:39], v8 offset:1120
    ds_read_b128 v[20:23], v6 offset:4352
    ds_read_b128 v[24:27], v6 offset:6400
    ds_read_b128 v[28:31], v6 offset:8448
    ds_read_b128 v[32:35], v6 offset:10496
    s_waitcnt lgkmcnt(4)
    v_or3_b32 v36, v36, v37, v38
    v_or_b32 v36, v36, v39
    v_cmp_ne_u32 vcc, 0, v36

    s_cbranch_vccz L_so4_ok
    s_sub_u32 s35, s35, 1
    s_cbranch_scc0 L_so4
L_so4_ok:

    s_cmp_eq_u32 s94, 1
    s_waitcnt lgkmcnt(2)
    v_pk_add_f32 v[20:21], v[20:21], v[24:25]
    v_pk_add_f32 v[22:23], v[22:23], v[26:27]
    s_waitcnt lgkmcnt(0)
    v_pk_add_f32 v[28:29], v[28:29], v[32:33]
    v_pk_add_f32 v[30:31], v[30:31], v[34:35]
    v_pk_add_f32 v[20:21], v[20:21], v[28:29]
    v_pk_add_f32 v[22:23], v[22:23], v[30:31]
    v_and_or_b32 v20, v20, v7, s36
    v_and_or_b32 v21, v21, v7, s37
    v_and_or_b32 v22, v22, v7, s38
    v_and_or_b32 v23, v23, v7, s39

    s_cbranch_scc1 L_st5p
    buffer_store_dwordx4 v[20:23], v5, s[40:43], s68 offen sc1
    s_branch L_st5e
L_st5p:
    buffer_store_dwordx4 v[20:23], v5, s[40:43], s68 offen
L_st5e:

    ds_write_b32 v3, v8 offset:1152
    s_endpgm
L_qkW:
    ds_read_b128 v[32:35], v15 offset:0
    ds_read_b128 v[36:39], v15 offset:64
    ds_read_b128 v[40:43], v15 offset:128
    ds_read_b128 v[44:47], v15 offset:192
    ds_read_b128 v[48:51], v15 offset:256
    ds_read_b128 v[52:55], v15 offset:320
    ds_read_b128 v[56:59], v15 offset:384
    ds_read_b128 v[60:63], v15 offset:448
    v_readfirstlane_b32 s94, v9
    s_waitcnt lgkmcnt(7)
    v_mfma_f32_16x16x32_bf16 v[20:23], v[64:67], v[32:35], 0
    v_mfma_f32_16x16x32_bf16 v[24:27], v[68:71], v[32:35], 0
    v_mfma_f32_16x16x32_bf16 v[28:31], v[72:75], v[32:35], 0
    s_waitcnt lgkmcnt(6)
    v_mfma_f32_16x16x32_bf16 v[20:23], v[76:79], v[36:39], v[20:23]
    v_mfma_f32_16x16x32_bf16 v[24:27], v[80:83], v[36:39], v[24:27]
    v_mfma_f32_16x16x32_bf16 v[28:31], v[84:87], v[36:39], v[28:31]
    s_waitcnt lgkmcnt(5)
    v_mfma_f32_16x16x32_bf16 v[20:23], v[88:91], v[40:43], v[20:23]
    v_mfma_f32_16x16x32_bf16 v[24:27], v[92:95], v[40:43], v[24:27]
    v_mfma_f32_16x16x32_bf16 v[28:31], v[96:99], v[40:43], v[28:31]
    s_waitcnt lgkmcnt(4)
    v_mfma_f32_16x16x32_bf16 v[20:23], v[100:103], v[44:47], v[20:23]
    v_mfma_f32_16x16x32_bf16 v[24:27], v[104:107], v[44:47], v[24:27]
    v_mfma_f32_16x16x32_bf16 v[28:31], v[108:111], v[44:47], v[28:31]
    s_waitcnt lgkmcnt(3)
    v_mfma_f32_16x16x32_bf16 v[20:23], v[112:115], v[48:51], v[20:23]
    v_mfma_f32_16x16x32_bf16 v[24:27], v[116:119], v[48:51], v[24:27]
    v_mfma_f32_16x16x32_bf16 v[28:31], v[120:123], v[48:51], v[28:31]
    s_waitcnt lgkmcnt(2)
    v_mfma_f32_16x16x32_bf16 v[20:23], v[124:127], v[52:55], v[20:23]
    v_mfma_f32_16x16x32_bf16 v[24:27], v[128:131], v[52:55], v[24:27]
    v_mfma_f32_16x16x32_bf16 v[28:31], v[132:135], v[52:55], v[28:31]
    s_waitcnt lgkmcnt(1)
    v_mfma_f32_16x16x32_bf16 v[20:23], v[136:139], v[56:59], v[20:23]
    v_mfma_f32_16x16x32_bf16 v[24:27], v[140:143], v[56:59], v[24:27]
    v_mfma_f32_16x16x32_bf16 v[28:31], v[144:147], v[56:59], v[28:31]
    s_waitcnt lgkmcnt(0)
    v_mfma_f32_16x16x32_bf16 v[20:23], v[148:151], v[60:63], v[20:23]
    v_mfma_f32_16x16x32_bf16 v[24:27], v[152:155], v[60:63], v[24:27]
    v_mfma_f32_16x16x32_bf16 v[28:31], v[156:159], v[60:63], v[28:31]
    s_nop 5
    v_cvt_pk_bf16_f32 v33, v20, v21
    v_cvt_pk_bf16_f32 v35, v22, v23
    v_cvt_pk_bf16_f32 v37, v24, v25
    v_cvt_pk_bf16_f32 v39, v26, v27
    v_cvt_pk_bf16_f32 v41, v28, v29
    v_cvt_pk_bf16_f32 v43, v30, v31
    v_lshlrev_b32 v32, 16, v33
    v_and_b32 v33, s60, v33
    v_lshlrev_b32 v34, 16, v35
    v_and_b32 v35, s60, v35
    v_lshlrev_b32 v36, 16, v37
    v_and_b32 v37, s60, v37
    v_lshlrev_b32 v38, 16, v39
    v_and_b32 v39, s60, v39
    v_lshlrev_b32 v40, 16, v41
    v_and_b32 v41, s60, v41
    v_lshlrev_b32 v42, 16, v43
    v_max3_f32 v44, v32, v33, v34
    v_max3_f32 v45, v37, v38, v39
    v_max3_f32 v44, v44, v35, v36
    v_max3_f32 v45, v45, v40, v41
    v_max_f32 v45, v45, v42
    v_max_f32 v44, v44, v45
    v_mov_b32 v45, v44
    s_nop 1
    v_permlane16_swap_b32 v44, v45
    v_max_f32 v44, v44, v45
    v_mov_b32 v45, v44
    s_nop 1
    v_permlane32_swap_b32 v44, v45
    v_max_f32 v44, v44, v45
    ds_write_b32 v3, v44 offset:1024

    v_sub_f32 v32, v32, v44
    v_sub_f32 v33, v33, v44
    v_sub_f32 v34, v34, v44
    v_sub_f32 v35, v35, v44
    v_sub_f32 v36, v36, v44
    v_sub_f32 v37, v37, v44
    v_sub_f32 v38, v38, v44
    v_sub_f32 v39, v39, v44
    v_sub_f32 v40, v40, v44
    v_sub_f32 v41, v41, v44
    v_sub_f32 v42, v42, v44
    v_mul_f32 v32, s61, v32
    v_mul_f32 v33, s61, v33
    v_mul_f32 v34, s61, v34
    v_mul_f32 v35, s61, v35
    v_mul_f32 v36, s61, v36
    v_mul_f32 v37, s61, v37
    v_mul_f32 v38, s61, v38
    v_mul_f32 v39, s61, v39
    v_mul_f32 v40, s61, v40
    v_mul_f32 v41, s61, v41
    v_mul_f32 v42, s61, v42
    v_exp_f32 v32, v32
    v_exp_f32 v33, v33
    v_exp_f32 v34, v34
    v_exp_f32 v35, v35
    v_exp_f32 v36, v36
    v_exp_f32 v37, v37
    v_exp_f32 v38, v38
    v_exp_f32 v39, v39
    v_exp_f32 v40, v40
    v_exp_f32 v41, v41
    v_exp_f32 v42, v42
    v_and_b32 v15, 12, v3
    v_lshrrev_b32 v1, 5, v0
    v_lshlrev_b32 v1, 4, v1
    v_or_b32 v15, v15, v1

    v_add_f32 v44, v32, v33
    v_add_f32 v45, v37, v38
    v_add_f32 v44, v44, v34
    v_add_f32 v45, v45, v39
    v_add_f32 v44, v44, v35
    v_add_f32 v45, v45, v40
    v_add_f32 v44, v44, v36
    v_add_f32 v45, v45, v41
    v_add_f32 v45, v45, v42
    v_add_f32 v44, v44, v45
    v_mov_b32 v45, v44
    v_cvt_pk_bf16_f32 v120, v32, v32
    v_cvt_pk_bf16_f32 v121, v33, v33
    v_permlane16_swap_b32 v44, v45
    v_add_f32 v44, v44, v45
    v_mov_b32 v45, v44
    v_cvt_pk_bf16_f32 v122, v34, v34
    v_cvt_pk_bf16_f32 v123, v35, v35
    v_permlane32_swap_b32 v44, v45
    v_add_f32 v44, v44, v45
    ds_write_b32 v3, v44 offset:1056

    v_cvt_pk_bf16_f32 v124, v36, v36
    v_cvt_pk_bf16_f32 v125, v37, v37
    v_cvt_pk_bf16_f32 v126, v38, v38
    v_cvt_pk_bf16_f32 v127, v39, v39
    v_cvt_pk_bf16_f32 v128, v40, v40
    v_cvt_pk_bf16_f32 v129, v41, v41
    v_cvt_pk_bf16_f32 v130, v42, v42
    s_setpc_b64 s[96:97]
L_q2:

    s_load_dword s34, s[30:31], 0
    s_setprio 3
    v_lshlrev_b32 v7, 3, v4
    s_getreg_b32 s94, hwreg(HW_REG_XCC_ID, 0, 4)

    s_mov_b32 s42, 1048576
    s_mov_b32 s43, 0x20000

    s_mov_b64 s[40:41], s[30:31]
    v_lshlrev_b32 v1, 2, v0
    v_mov_b32 v2, -1
    ds_write_b32 v1, v2 offset:1024

    s_mov_b64 s[60:61], 0xffff
    v_lshlrev_b32 v1, 4, v0
    v_lshlrev_b64 v[16:17], v1, s[60:61]
    v_bfe_i32 v1, v0, 2, 1
    v_and_b32 v18, v16, v1
    v_and_b32 v19, v17, v1
    v_xor_b32 v16, v16, v18
    v_xor_b32 v17, v17, v19

    v_and_b32 v10, 7, v0
    v_bfe_u32 v1, v0, 4, 1
    v_lshl_or_b32 v10, v10, 1, v1
    v_bfe_u32 v1, v0, 3, 1
    v_lshl_or_b32 v10, v10, 1, v1
    v_lshrrev_b32 v1, 5, v0
    v_lshl_or_b32 v10, v10, 1, v1

    s_cmp_eq_u32 s3, 0
    s_cselect_b32 s69, 28, 0
    v_lshlrev_b32 v8, 7, v0
    v_cmp_gt_u32 vcc, s69, v0
    s_nop 1
    v_cndmask_b32 v8, 2.0, v8, vcc
    s_lshl_b32 s69, s32, 12
    s_add_u32 s69, s69, 65536

    s_lshl_b32 s56, s3, 8
    v_lshl_add_u32 v11, v10, 2, s56
    s_lshl_b32 s65, s32, 3
    s_add_u32 s65, s65, s33
    s_lshl_b32 s65, s65, 8
    s_add_u32 s65, s65, 24576
    v_and_b32 v3, 31, v0
    v_lshlrev_b32 v3, 3, v3
    s_mov_b32 s62, 991054117
    s_mov_b32 s63, 0xffff0000
    s_mov_b32 s64, 925353388
    s_movk_i32 s66, 4096
    s_movk_i32 s67, 11264
    s_waitcnt lgkmcnt(0)

    s_add_u32 s34, s34, 2654435761
    s_and_b32 s36, s34, 0xff
    s_bfe_u32 s37, s34, 0x80008
    s_bfe_u32 s38, s34, 0x80010
    s_lshr_b32 s39, s34, 24

    s_waitcnt vmcnt(7)
    v_lshlrev_b32 v64, 16, v12
    v_and_b32 v65, s63, v12
    v_lshlrev_b32 v66, 16, v13
    v_and_b32 v67, s63, v13
    v_lshlrev_b32 v68, 16, v14
    v_and_b32 v69, s63, v14
    v_lshlrev_b32 v70, 16, v15
    v_and_b32 v71, s63, v15
    v_lshlrev_b32 v9, 16, v9
    v_add_f32 v12, v64, v65
    v_mul_f32 v13, v64, v64

    v_fmac_f32 v13, v65, v65
    v_add_f32 v12, v12, v66
    v_fmac_f32 v13, v66, v66
    v_add_f32 v12, v12, v67
    v_fmac_f32 v13, v67, v67
    v_add_f32 v12, v12, v68
    v_fmac_f32 v13, v68, v68
    v_add_f32 v12, v12, v69
    v_fmac_f32 v13, v69, v69
    v_add_f32 v12, v12, v70
    v_fmac_f32 v13, v70, v70
    v_add_f32 v12, v12, v71
    v_fmac_f32 v13, v71, v71
    s_nop 0
    v_add_f32_dpp v12, v12, v12 row_shr:1 row_mask:0xf bank_mask:0xf
    v_add_f32_dpp v13, v13, v13 row_shr:1 row_mask:0xf bank_mask:0xf
    s_nop 0
    v_add_f32_dpp v12, v12, v12 row_shr:2 row_mask:0xf bank_mask:0xf
    v_add_f32_dpp v13, v13, v13 row_shr:2 row_mask:0xf bank_mask:0xf
    s_nop 0
    v_add_f32_dpp v12, v12, v12 row_shr:4 row_mask:0xf bank_mask:0xf
    v_add_f32_dpp v13, v13, v13 row_shr:4 row_mask:0xf bank_mask:0xf
    s_nop 0
    v_add_f32_dpp v12, v12, v12 row_shr:8 row_mask:0xf bank_mask:0xf
    v_add_f32_dpp v13, v13, v13 row_shr:8 row_mask:0xf bank_mask:0xf
    s_nop 0
    v_add_f32_dpp v12, v12, v12 row_bcast:15 row_mask:0xa bank_mask:0xf
    v_add_f32_dpp v13, v13, v13 row_bcast:15 row_mask:0xa bank_mask:0xf
    s_nop 0
    v_add_f32_dpp v12, v12, v12 row_bcast:31 row_mask:0xc bank_mask:0xf
    v_add_f32_dpp v13, v13, v13 row_bcast:31 row_mask:0xc bank_mask:0xf
    v_readlane_b32 s60, v12, 63
    v_readlane_b32 s61, v13, 63
    s_nop 0
    v_mov_b32 v12, s60
    v_mov_b32 v13, s61

    v_pk_mul_f32 v[14:15], v[12:13], s[62:63] op_sel_hi:[1,0]
    s_nop 0
    v_fma_f32 v15, -v14, v14, v15
    v_cvt_pk_bf16_f32 v14, 0, v14
    v_max_f32 v15, 0, v15
    v_sub_f32 v14, v9, v14
    v_cvt_pk_bf16_f32 v15, 0, v15
    v_cvt_pk_bf16_f32 v14, 0, v14
    v_add_f32 v15, s64, v15
    v_cvt_pk_bf16_f32 v15, 0, v15
    v_sqrt_f32 v15, v15
    s_nop 0
    v_cvt_pk_bf16_f32 v15, 0, v15
    v_rcp_f32 v15, v15
    s_nop 0
    v_mul_f32 v14, v14, v15

    v_cvt_pk_bf16_f32 v9, 0, v14
    s_cmp_eq_u32 s3, 0
    s_cbranch_scc0 L_xp6
    s_lshl_b32 s56, s32, 5
    s_add_u32 s56, s56, s33
    s_lshl_b32 s56, s56, 7
    s_add_u32 s56, s56, 65536
    v_mov_b32 v72, s94
    v_mov_b32 v73, s34
    v_lshlrev_b32 v74, 3, v0
    s_mov_b64 exec, 65535
    buffer_store_dwordx2 v[72:73], v74, s[40:43], s56 offen

    s_mov_b64 exec, -1
L_xp6:
    s_waitcnt vmcnt(0)
    s_movk_i32 s35, 20000
L_pa7:
    buffer_load_dwordx2 v[64:65], v7, s[40:43], s66 offen sc1
    buffer_load_dwordx2 v[66:67], v7, s[40:43], s66 offen offset:3584 sc1
    buffer_load_dwordx2 v[68:69], v7, s[40:43], s67 offen sc1
    buffer_load_dwordx2 v[70:71], v7, s[40:43], s67 offen offset:3584 sc1
    buffer_load_dwordx2 v[72:73], v8, s[40:43], s69 offen sc1
    s_waitcnt vmcnt(0)
    v_bitop3_b32 v12, v65, v67, s34 bitop3:0x7e
    v_bitop3_b32 v13, v69, v71, s34 bitop3:0x7e
    v_add_f32 v64, v64, v68
    v_or_b32 v12, v12, v13
    v_add_f32 v66, v66, v70
    v_cmp_ne_u32 vcc, 0, v12

    s_cbranch_vccz L_pa7_ok

    s_sub_u32 s35, s35, 1
    s_cbranch_scc0 L_pa7
L_pa7_ok:

    v_cvt_pk_bf16_f32 v66, 0, v66
    v_cvt_pk_bf16_f32 v64, 0, v64
    v_add_f32 v66, 1.0, v66

    v_cvt_pk_bf16_f32 v66, 0, v66
    v_mul_f32 v66, v66, v9
    v_cvt_pk_bf16_f32 v66, 0, v66
    v_add_f32 v66, v66, v64
    v_cvt_pk_bf16_f32 v13, v66, v66
    v_cvt_pk_bf16_f32 v12, v66, v66

    s_nop 1
    v_mov_b32_dpp v12, v13 row_shr:4 row_mask:0xf bank_mask:0xa
    v_mov_b32_dpp v13, v13 row_shl:4 row_mask:0xf bank_mask:0x5

    s_nop 0
    v_and_b32_dpp v20, v12, v16 quad_perm:[0,0,0,0] row_mask:0xf bank_mask:0xf
    v_and_b32_dpp v21, v12, v17 quad_perm:[0,0,0,0] row_mask:0xf bank_mask:0xf
    v_and_b32_dpp v22, v12, v18 quad_perm:[0,0,0,0] row_mask:0xf bank_mask:0xf
    v_and_b32_dpp v23, v12, v19 quad_perm:[0,0,0,0] row_mask:0xf bank_mask:0xf
    v_and_b32_dpp v24, v12, v16 quad_perm:[1,1,1,1] row_mask:0xf bank_mask:0xf
    v_and_b32_dpp v25, v12, v17 quad_perm:[1,1,1,1] row_mask:0xf bank_mask:0xf
    v_and_b32_dpp v26, v12, v18 quad_perm:[1,1,1,1] row_mask:0xf bank_mask:0xf
    v_and_b32_dpp v27, v12, v19 quad_perm:[1,1,1,1] row_mask:0xf bank_mask:0xf
    v_mfma_f32_16x16x32_bf16 v[28:31], v[20:23], v[32:35], 0
    v_and_b32_dpp v20, v12, v16 quad_perm:[2,2,2,2] row_mask:0xf bank_mask:0xf
    v_and_b32_dpp v21, v12, v17 quad_perm:[2,2,2,2] row_mask:0xf bank_mask:0xf
    v_and_b32_dpp v22, v12, v18 quad_perm:[2,2,2,2] row_mask:0xf bank_mask:0xf
    v_and_b32_dpp v23, v12, v19 quad_perm:[2,2,2,2] row_mask:0xf bank_mask:0xf
    v_mfma_f32_16x16x32_bf16 v[28:31], v[24:27], v[36:39], v[28:31]
    v_and_b32_dpp v24, v12, v16 quad_perm:[3,3,3,3] row_mask:0xf bank_mask:0xf
    v_and_b32_dpp v25, v12, v17 quad_perm:[3,3,3,3] row_mask:0xf bank_mask:0xf
    v_and_b32_dpp v26, v12, v18 quad_perm:[3,3,3,3] row_mask:0xf bank_mask:0xf
    v_and_b32_dpp v27, v12, v19 quad_perm:[3,3,3,3] row_mask:0xf bank_mask:0xf
    v_mfma_f32_16x16x32_bf16 v[28:31], v[20:23], v[40:43], v[28:31]
    v_and_b32_dpp v20, v13, v16 quad_perm:[0,0,0,0] row_mask:0xf bank_mask:0xf
    v_and_b32_dpp v21, v13, v17 quad_perm:[0,0,0,0] row_mask:0xf bank_mask:0xf
    v_and_b32_dpp v22, v13, v18 quad_perm:[0,0,0,0] row_mask:0xf bank_mask:0xf
    v_and_b32_dpp v23, v13, v19 quad_perm:[0,0,0,0] row_mask:0xf bank_mask:0xf
    v_mfma_f32_16x16x32_bf16 v[28:31], v[24:27], v[44:47], v[28:31]
    v_and_b32_dpp v24, v13, v16 quad_perm:[1,1,1,1] row_mask:0xf bank_mask:0xf
    v_and_b32_dpp v25, v13, v17 quad_perm:[1,1,1,1] row_mask:0xf bank_mask:0xf
    v_and_b32_dpp v26, v13, v18 quad_perm:[1,1,1,1] row_mask:0xf bank_mask:0xf
    v_and_b32_dpp v27, v13, v19 quad_perm:[1,1,1,1] row_mask:0xf bank_mask:0xf
    v_mfma_f32_16x16x32_bf16 v[28:31], v[20:23], v[48:51], v[28:31]
    v_and_b32_dpp v20, v13, v16 quad_perm:[2,2,2,2] row_mask:0xf bank_mask:0xf
    v_and_b32_dpp v21, v13, v17 quad_perm:[2,2,2,2] row_mask:0xf bank_mask:0xf
    v_and_b32_dpp v22, v13, v18 quad_perm:[2,2,2,2] row_mask:0xf bank_mask:0xf
    v_and_b32_dpp v23, v13, v19 quad_perm:[2,2,2,2] row_mask:0xf bank_mask:0xf
    v_mfma_f32_16x16x32_bf16 v[28:31], v[24:27], v[52:55], v[28:31]
    s_nop 0
    v_mfma_f32_16x16x32_bf16 v[28:31], v[20:23], v[56:59], v[28:31]
    s_getreg_b32 s94, hwreg(HW_REG_XCC_ID, 0, 4)
    v_xor_b32 v73, s34, v73
    v_bitop3_b32 v72, v72, v73, s94 bitop3:0xde
    v_cmp_ne_u32 vcc, 0, v72
    s_and_b32 s94, vcc_lo, 0x0fffffff
    s_cselect_b32 s94, 0, 1

    s_nop 1
    v_permlane32_swap_b32 v28, v29
    v_permlane32_swap_b32 v30, v31
    s_nop 0
    v_add_f32_dpp v14, v29, v28 row_ror:8 row_mask:0xf bank_mask:0x3
    s_nop 1
    v_add_f32_dpp v14, v30, v31 row_ror:8 row_mask:0xf bank_mask:0xc

    ds_write_b32 v11, v14 offset:2304
    s_cmp_eq_u32 s3, 0
    s_waitcnt lgkmcnt(0)
    s_barrier
    s_cbranch_scc0 L_qdone

    ds_read_b64 v[64:65], v3 offset:2304
    ds_read_b64 v[66:67], v3 offset:2560
    ds_read_b64 v[68:69], v3 offset:2816
    ds_read_b64 v[70:71], v3 offset:3072
    ds_read_b64 v[72:73], v3 offset:3328
    ds_read_b64 v[74:75], v3 offset:3584
    ds_read_b64 v[76:77], v3 offset:3840
    ds_read_b64 v[78:79], v3 offset:4096
    s_cmp_eq_u32 s94, 1
    s_waitcnt lgkmcnt(4)
    v_pk_add_f32 v[64:65], v[64:65], v[66:67]
    v_pk_add_f32 v[68:69], v[68:69], v[70:71]
    s_waitcnt lgkmcnt(0)
    v_pk_add_f32 v[72:73], v[72:73], v[74:75]
    v_pk_add_f32 v[76:77], v[76:77], v[78:79]
    v_pk_add_f32 v[64:65], v[64:65], v[68:69]
    v_pk_add_f32 v[72:73], v[72:73], v[76:77]
    v_pk_add_f32 v[64:65], v[64:65], v[72:73]
    v_mov_b32 v13, s34
    v_cvt_pk_bf16_f32 v12, v64, v65
    s_mov_b32 exec_hi, 0

    s_cbranch_scc1 L_st8p
    buffer_store_dwordx2 v[12:13], v3, s[40:43], s65 offen sc1
    s_branch L_st8e
L_st8p:
    buffer_store_dwordx2 v[12:13], v3, s[40:43], s65 offen
L_st8e:

    s_mov_b32 exec_hi, -1
    s_branch L_fgather
L_qhelp:

    s_waitcnt vmcnt(0)
    s_branch L_fend
L_qdone:
    s_cmp_lt_u32 s3, 4
    s_cbranch_scc1 L_qhelp

L_streamQ:
    s_setprio 1
    s_sub_u32 s56, s3, 4
    s_lshl_b32 s57, s33, 2
    s_add_u32 s57, s57, s56

    s_movk_i32 s61, 18
    s_mul_i32 s58, s57, 18
    s_add_u32 s58, s58, 12288

    s_lshl_b32 s58, s58, 9
    s_lshl_b32 s60, s32, 23

    s_add_u32 s62, s58, s60
    s_lshl_b32 s60, s61, 9
    s_add_u32 s46, s62, s60

    s_mov_b32 s50, s46
    s_add_u32 s63, s62, 4096
    s_add_u32 s64, s62, 8192
    s_mul_i32 s68, s56, 24576
    s_add_u32 s68, s68, 12544
    s_mov_b32 m0, s68
    v_and_b32 v1, 31, v0
    v_lshrrev_b32 v10, 5, v0
    v_lshlrev_b32 v11, 2, v10
    v_xor_b32 v1, v1, v11
    v_lshlrev_b32 v1, 4, v1
    v_lshl_or_b32 v2, v10, 9, v1
    v_xor_b32 v3, 0x80, v2
    v_xor_b32 v4, 16, v2
    v_xor_b32 v5, 0x90, v2
    v_xor_b32 v6, 32, v2
    v_xor_b32 v7, 0xa0, v2
    v_xor_b32 v8, 48, v2
    v_xor_b32 v9, 0xb0, v2

    v_lshrrev_b32 v20, 4, v0
    v_and_b32 v21, 15, v0
    v_lshlrev_b32 v10, 9, v20
    v_lshl_or_b32 v10, v21, 4, v10
    s_waitcnt lgkmcnt(0)
    s_mov_b64 s[44:45], s[6:7]
    s_mov_b64 s[48:49], s[8:9]
    buffer_load_dwordx4 v2, s[44:47], s62 offen offset:0 nt lds
    s_load_dword s34, s[30:31], 0
    buffer_load_dwordx4 v3, s[44:47], s62 offen offset:1024 nt lds
    buffer_load_dwordx4 v4, s[44:47], s62 offen offset:2048 nt lds
    buffer_load_dwordx4 v5, s[44:47], s62 offen offset:3072 nt lds
    s_add_u32 m0, s68, 4096
    s_nop 0
    buffer_load_dwordx4 v6, s[44:47], s63 offen offset:0 nt lds
    buffer_load_dwordx4 v7, s[44:47], s63 offen offset:1024 nt lds
    buffer_load_dwordx4 v8, s[44:47], s63 offen offset:2048 nt lds
    buffer_load_dwordx4 v9, s[44:47], s63 offen offset:3072 nt lds
    s_add_u32 m0, s68, 8192
    s_waitcnt vmcnt(7)
    buffer_load_dwordx4 v2, s[44:47], s64 offen offset:0 nt lds
    s_waitcnt vmcnt(7)
    buffer_load_dwordx4 v[160:163], v10, s[48:51], s62 offen offset:0 nt
    v_lshrrev_b32 v22, 2, v21
    v_and_b32 v23, 3, v21
    v_lshl_add_u32 v22, v23, 2, v22
    v_xor_b32 v23, v20, v21
    v_lshlrev_b32 v23, 4, v23
    v_lshl_add_u32 v22, v22, 9, v23
    v_add_u32 v11, s68, v22
    v_xor_b32 v12, 64, v11
    v_xor_b32 v13, 0x80, v11
    v_xor_b32 v14, 0xc0, v11
    v_bfe_u32 v22, v0, 3, 1
    v_lshlrev_b32 v23, 4, v20
    v_lshl_add_u32 v15, v22, 9, v23
    v_lshlrev_b32 v1, 4, v22
    s_lshl_b32 s57, s56, 2
    v_add_u32 v3, s57, v1
    v_sub_u32 v2, s61, v20

    v_cmp_lt_i32 s[12:13], 16, v2
    v_lshrrev_b32 v22, 5, v0
    v_lshlrev_b32 v22, 10, v22
    v_lshl_or_b32 v22, v21, 5, v22
    v_bfe_u32 v23, v0, 4, 1
    v_lshl_or_b32 v22, v23, 4, v22
    s_lshl_b32 s57, s56, 11
    v_add_u32 v4, s57, v22
    s_lshl_b32 s57, s56, 9
    v_and_b32 v5, 31, v0
    v_lshlrev_b32 v5, 4, v5
    v_add_u32 v6, s57, v5
    s_lshl_b32 s57, s32, 1
    s_lshr_b32 s58, s56, 1
    s_add_u32 s57, s57, s58
    s_lshl_b32 s57, s57, 5
    s_add_u32 s57, s57, s33
    s_lshl_b32 s57, s57, 10
    s_and_b32 s58, s56, 1
    s_lshl_b32 s58, s58, 9
    s_add_u32 s57, s57, s58
    s_add_u32 s68, s57, 262144
    s_mov_b64 s[40:41], s[30:31]

    s_mov_b32 s42, 1048576
    s_mov_b32 s43, 0x20000

    s_mov_b64 s[56:57], 0xffff
    v_lshlrev_b32 v22, 4, v0
    v_lshlrev_b64 v[16:17], v22, s[56:57]
    v_bfe_i32 v22, v0, 2, 1
    v_and_b32 v18, v16, v22
    v_and_b32 v19, v17, v22
    v_xor_b32 v16, v16, v18
    v_xor_b32 v17, v17, v19

    s_mov_b32 s60, 0xffff0000
    s_mov_b32 s61, 1035512379
    v_mov_b32 v2, 0xff7f0000
    v_mov_b32 v7, 0xffffff00
    v_mov_b32 v8, 0
    s_waitcnt lgkmcnt(0)

    s_add_u32 s34, s34, 2654435761
    s_and_b32 s36, s34, 0xff
    s_bfe_u32 s37, s34, 0x80008
    s_bfe_u32 s38, s34, 0x80010
    s_lshr_b32 s39, s34, 24

    s_waitcnt vmcnt(7)
    buffer_load_dwordx4 v[164:167], v10, s[48:51], s62 offen offset:256 nt
    s_waitcnt vmcnt(7)
    buffer_load_dwordx4 v[168:171], v10, s[48:51], s62 offen offset:2048 nt
    s_waitcnt vmcnt(7)
    buffer_load_dwordx4 v[172:175], v10, s[48:51], s62 offen offset:2304 nt
    s_waitcnt vmcnt(7)
    buffer_load_dwordx4 v[176:179], v10, s[48:51], s63 offen offset:0 nt
    s_waitcnt vmcnt(7)
    buffer_load_dwordx4 v[180:183], v10, s[48:51], s63 offen offset:256 nt
    s_waitcnt vmcnt(7)
    buffer_load_dwordx4 v[184:187], v10, s[48:51], s63 offen offset:2048 nt
    s_waitcnt vmcnt(7)
    buffer_load_dwordx4 v[188:191], v10, s[48:51], s63 offen offset:2304 nt
    ds_read_b128 v[64:67], v11 offset:0
    ds_read_b128 v[68:71], v11 offset:8192
    ds_read_b128 v[76:79], v12 offset:0
    ds_read_b128 v[80:83], v12 offset:8192
    ds_read_b128 v[88:91], v13 offset:0
    ds_read_b128 v[92:95], v13 offset:8192
    ds_read_b128 v[100:103], v14 offset:0
    ds_read_b128 v[104:107], v14 offset:8192
    s_waitcnt vmcnt(7) lgkmcnt(0)
    buffer_load_dwordx4 v[192:195], v10, s[48:51], s64 offen offset:0 nt
    ds_read_b128 v[112:115], v11 offset:256
    ds_read_b128 v[116:119], v11 offset:8448
    ds_read_b128 v[124:127], v12 offset:256
    ds_read_b128 v[128:131], v12 offset:8448
    ds_read_b128 v[136:139], v13 offset:256
    ds_read_b128 v[140:143], v13 offset:8448
    ds_read_b128 v[148:151], v14 offset:256
    ds_read_b128 v[152:155], v14 offset:8448
    ds_read_b32 v9, v8 offset:1188
    s_waitcnt lgkmcnt(0)
    v_cmp_ne_u32 vcc, -1, v9
    s_cbranch_vccnz L_stQ8

    s_waitcnt vmcnt(7) lgkmcnt(0)
    buffer_load_dwordx4 v[196:199], v10, s[48:51], s64 offen offset:256 nt
    ds_write_b32 v3, v8 offset:1088
    s_movk_i32 s35, 20000
L_sq9:
    ds_read_b32 v9, v8 offset:1188
    s_waitcnt lgkmcnt(0)
    v_cmp_eq_u32 vcc, -1, v9

    s_cbranch_vccz L_sq9_ok
    s_sub_u32 s35, s35, 1
    s_cbranch_scc0 L_sq9
L_sq9_ok:

    s_call_b64 s[96:97], L_qkQ
L_qkrQ:
    s_branch L_qkdQ

L_stQ8:
    buffer_load_dwordx4 v[196:199], v10, s[48:51], s64 offen offset:256 nt
    ds_write_b32 v3, v8 offset:1088
    s_call_b64 s[96:97], L_qkQ
L_srQ8:
    s_branch L_cbQ10

L_cbQ10:
L_qkdQ:
    s_setprio 2

    s_movk_i32 s35, 20000
L_sm10:
    ds_read_b128 v[44:47], v1 offset:1024
    ds_read_b32 v49, v15 offset:1024
    s_waitcnt lgkmcnt(1)
    v_or3_b32 v48, v44, v45, v46
    v_max3_f32 v44, v44, v45, v46
    v_bitop3_b32 v48, v48, v47, s60 bitop3:0x54
    v_max_f32 v44, v44, v47
    v_cmp_ne_u32 vcc, 0, v48

    s_cbranch_vccz L_sm10_ok
    s_sub_u32 s35, s35, 1
    s_cbranch_scc0 L_sm10
L_sm10_ok:

    s_waitcnt lgkmcnt(0)
    v_sub_f32 v44, v49, v44
    v_mul_f32 v44, s61, v44
    v_exp_f32 v44, v44

    v_and_b32 v64, v120, v16
    v_and_b32 v65, v120, v17
    v_and_b32 v66, v120, v18
    v_and_b32 v67, v120, v19
    v_and_b32 v68, v121, v16
    v_and_b32 v69, v121, v17
    v_and_b32 v70, v121, v18
    v_and_b32 v71, v121, v19
    s_waitcnt vmcnt(9)
    v_mfma_f32_16x16x32_bf16 v[112:115], v[64:67], v[160:163], 0
    s_waitcnt vmcnt(8)
    v_mfma_f32_16x16x32_bf16 v[116:119], v[64:67], v[164:167], 0
    v_and_b32 v72, v122, v16
    v_and_b32 v73, v122, v17
    v_and_b32 v74, v122, v18
    v_and_b32 v75, v122, v19
    s_waitcnt vmcnt(7)
    v_mfma_f32_16x16x32_bf16 v[112:115], v[68:71], v[168:171], v[112:115]
    s_waitcnt vmcnt(6)
    v_mfma_f32_16x16x32_bf16 v[116:119], v[68:71], v[172:175], v[116:119]
    v_and_b32 v76, v123, v16
    v_and_b32 v77, v123, v17
    v_and_b32 v78, v123, v18
    v_and_b32 v79, v123, v19
    s_waitcnt vmcnt(5)
    v_mfma_f32_16x16x32_bf16 v[112:115], v[72:75], v[176:179], v[112:115]
    s_waitcnt vmcnt(4)
    v_mfma_f32_16x16x32_bf16 v[116:119], v[72:75], v[180:183], v[116:119]
    v_and_b32 v80, v124, v16
    v_and_b32 v81, v124, v17
    v_and_b32 v82, v124, v18
    v_and_b32 v83, v124, v19
    s_waitcnt vmcnt(3)
    v_mfma_f32_16x16x32_bf16 v[112:115], v[76:79], v[184:187], v[112:115]
    s_waitcnt vmcnt(2)
    v_mfma_f32_16x16x32_bf16 v[116:119], v[76:79], v[188:191], v[116:119]
    s_waitcnt vmcnt(1)
    v_mfma_f32_16x16x32_bf16 v[112:115], v[80:83], v[192:195], v[112:115]
    s_waitcnt vmcnt(0)
    v_mfma_f32_16x16x32_bf16 v[116:119], v[80:83], v[196:199], v[116:119]
    s_nop 5
    v_pk_mul_f32 v[112:113], v[112:113], v[44:45] op_sel_hi:[1,0]
    v_pk_mul_f32 v[114:115], v[114:115], v[44:45] op_sel_hi:[1,0]
    v_pk_mul_f32 v[116:117], v[116:117], v[44:45] op_sel_hi:[1,0]
    v_pk_mul_f32 v[118:119], v[118:119], v[44:45] op_sel_hi:[1,0]
    ds_write_b128 v4, v[112:115] offset:4352
    ds_write_b128 v4, v[116:119] offset:4864
    ds_write_b32 v3, v8 offset:1120
    s_mov_b32 exec_hi, 0

    s_movk_i32 s35, 20000
L_so11:
    ds_read_b128 v[36:39], v8 offset:1120
    ds_read_b128 v[20:23], v6 offset:4352
    ds_read_b128 v[24:27], v6 offset:6400
    ds_read_b128 v[28:31], v6 offset:8448
    ds_read_b128 v[32:35], v6 offset:10496
    s_waitcnt lgkmcnt(4)
    v_or3_b32 v36, v36, v37, v38
    v_or_b32 v36, v36, v39
    v_cmp_ne_u32 vcc, 0, v36

    s_cbranch_vccz L_so11_ok
    s_sub_u32 s35, s35, 1
    s_cbranch_scc0 L_so11
L_so11_ok:

    s_cmp_eq_u32 s94, 1
    s_waitcnt lgkmcnt(2)
    v_pk_add_f32 v[20:21], v[20:21], v[24:25]
    v_pk_add_f32 v[22:23], v[22:23], v[26:27]
    s_waitcnt lgkmcnt(0)
    v_pk_add_f32 v[28:29], v[28:29], v[32:33]
    v_pk_add_f32 v[30:31], v[30:31], v[34:35]
    v_pk_add_f32 v[20:21], v[20:21], v[28:29]
    v_pk_add_f32 v[22:23], v[22:23], v[30:31]
    v_and_or_b32 v20, v20, v7, s36
    v_and_or_b32 v21, v21, v7, s37
    v_and_or_b32 v22, v22, v7, s38
    v_and_or_b32 v23, v23, v7, s39

    s_cbranch_scc1 L_st12p
    buffer_store_dwordx4 v[20:23], v5, s[40:43], s68 offen sc1
    s_branch L_st12e
L_st12p:
    buffer_store_dwordx4 v[20:23], v5, s[40:43], s68 offen
L_st12e:

    ds_write_b32 v3, v8 offset:1152
    s_endpgm
L_qkQ:
    ds_read_b128 v[32:35], v15 offset:0
    ds_read_b128 v[36:39], v15 offset:64
    ds_read_b128 v[40:43], v15 offset:128
    ds_read_b128 v[44:47], v15 offset:192
    ds_read_b128 v[48:51], v15 offset:256
    ds_read_b128 v[52:55], v15 offset:320
    ds_read_b128 v[56:59], v15 offset:384
    ds_read_b128 v[60:63], v15 offset:448
    v_readfirstlane_b32 s94, v9
    s_waitcnt lgkmcnt(7)
    v_mfma_f32_16x16x32_bf16 v[20:23], v[64:67], v[32:35], 0
    v_mfma_f32_16x16x32_bf16 v[24:27], v[68:71], v[32:35], 0
    s_waitcnt lgkmcnt(6)
    v_mfma_f32_16x16x32_bf16 v[20:23], v[76:79], v[36:39], v[20:23]
    v_mfma_f32_16x16x32_bf16 v[24:27], v[80:83], v[36:39], v[24:27]
    s_waitcnt lgkmcnt(5)
    v_mfma_f32_16x16x32_bf16 v[20:23], v[88:91], v[40:43], v[20:23]
    v_mfma_f32_16x16x32_bf16 v[24:27], v[92:95], v[40:43], v[24:27]
    s_waitcnt lgkmcnt(4)
    v_mfma_f32_16x16x32_bf16 v[20:23], v[100:103], v[44:47], v[20:23]
    v_mfma_f32_16x16x32_bf16 v[24:27], v[104:107], v[44:47], v[24:27]
    s_waitcnt lgkmcnt(3)
    v_mfma_f32_16x16x32_bf16 v[20:23], v[112:115], v[48:51], v[20:23]
    v_mfma_f32_16x16x32_bf16 v[24:27], v[116:119], v[48:51], v[24:27]
    s_waitcnt lgkmcnt(2)
    v_mfma_f32_16x16x32_bf16 v[20:23], v[124:127], v[52:55], v[20:23]
    v_mfma_f32_16x16x32_bf16 v[24:27], v[128:131], v[52:55], v[24:27]
    s_waitcnt lgkmcnt(1)
    v_mfma_f32_16x16x32_bf16 v[20:23], v[136:139], v[56:59], v[20:23]
    v_mfma_f32_16x16x32_bf16 v[24:27], v[140:143], v[56:59], v[24:27]
    s_waitcnt lgkmcnt(0)
    v_mfma_f32_16x16x32_bf16 v[20:23], v[148:151], v[60:63], v[20:23]
    v_mfma_f32_16x16x32_bf16 v[24:27], v[152:155], v[60:63], v[24:27]
    s_nop 6
    v_cvt_pk_bf16_f32 v33, v20, v21
    v_cvt_pk_bf16_f32 v35, v22, v23
    v_cvt_pk_bf16_f32 v37, v24, v25
    v_lshlrev_b32 v32, 16, v33
    v_and_b32 v33, s60, v33
    v_lshlrev_b32 v34, 16, v35
    v_and_b32 v35, s60, v35
    v_lshlrev_b32 v36, 16, v37
    v_cndmask_b32 v36, v2, v36, s[12:13]
    v_max_f32 v44, v32, v33
    v_max3_f32 v45, v34, v35, v36
    v_max_f32 v44, v44, v45
    v_mov_b32 v45, v44
    s_nop 1
    v_permlane16_swap_b32 v44, v45
    v_max_f32 v44, v44, v45
    v_mov_b32 v45, v44
    s_nop 1
    v_permlane32_swap_b32 v44, v45
    v_max_f32 v44, v44, v45
    ds_write_b32 v3, v44 offset:1024

    v_sub_f32 v32, v32, v44
    v_sub_f32 v33, v33, v44
    v_sub_f32 v34, v34, v44
    v_sub_f32 v35, v35, v44
    v_sub_f32 v36, v36, v44
    v_mul_f32 v32, s61, v32
    v_mul_f32 v33, s61, v33
    v_mul_f32 v34, s61, v34
    v_mul_f32 v35, s61, v35
    v_mul_f32 v36, s61, v36
    v_exp_f32 v32, v32
    v_exp_f32 v33, v33
    v_exp_f32 v34, v34
    v_exp_f32 v35, v35
    v_exp_f32 v36, v36
    v_and_b32 v15, 12, v3
    v_lshrrev_b32 v1, 5, v0
    v_lshlrev_b32 v1, 4, v1
    v_or_b32 v15, v15, v1

    v_add_f32 v44, v32, v33
    v_add_f32 v45, v34, v35
    v_add_f32 v45, v45, v36
    v_add_f32 v44, v44, v45
    v_mov_b32 v45, v44
    v_cvt_pk_bf16_f32 v120, v32, v32
    v_cvt_pk_bf16_f32 v121, v33, v33
    v_permlane16_swap_b32 v44, v45
    v_add_f32 v44, v44, v45
    v_mov_b32 v45, v44
    v_cvt_pk_bf16_f32 v122, v34, v34
    v_cvt_pk_bf16_f32 v123, v35, v35
    v_permlane32_swap_b32 v44, v45
    v_add_f32 v44, v44, v45
    ds_write_b32 v3, v44 offset:1056

    v_cvt_pk_bf16_f32 v124, v36, v36
    s_setpc_b64 s[96:97]
L_front:
    s_setprio 3
    s_getreg_b32 s94, hwreg(HW_REG_XCC_ID, 0, 4)

    v_lshlrev_b32 v1, 2, v0
    v_mov_b32 v2, -1
    ds_write_b32 v1, v2 offset:1024

    s_mov_b32 s42, 1048576
    s_mov_b32 s43, 0x20000

    s_waitcnt lgkmcnt(0)
    s_load_dword s34, s[30:31], 0
    s_barrier
    s_mov_b64 s[40:41], s[30:31]
    s_cmp_eq_u32 s3, 0
    s_cbranch_scc1 L_f0
    s_cmp_lt_u32 s33, 14
    s_waitcnt vmcnt(0) lgkmcnt(0)
    s_cbranch_scc1 L_fend

    s_add_u32 s34, s34, 2654435761
    s_and_b32 s36, s34, 0xff
    s_bfe_u32 s37, s34, 0x80008
    s_bfe_u32 s38, s34, 0x80010
    s_lshr_b32 s39, s34, 24

    s_branch L_fwo
L_f0:

    s_cmp_eq_u32 s3, 0
    s_cselect_b32 s69, 28, 0
    v_lshlrev_b32 v8, 7, v0
    v_cmp_gt_u32 vcc, s69, v0
    s_nop 1
    v_cndmask_b32 v8, 2.0, v8, vcc
    s_lshl_b32 s69, s32, 12
    s_add_u32 s69, s69, 65536

    s_waitcnt lgkmcnt(0)
    s_add_u32 s34, s34, 2654435761
    s_and_b32 s36, s34, 0xff
    s_bfe_u32 s37, s34, 0x80008
    s_bfe_u32 s38, s34, 0x80010
    s_lshr_b32 s39, s34, 24

    s_cmp_eq_u32 s3, 0
    s_cbranch_scc0 L_xp13
    s_lshl_b32 s56, s32, 5
    s_add_u32 s56, s56, s33
    s_lshl_b32 s56, s56, 7
    s_add_u32 s56, s56, 65536
    v_mov_b32 v72, s94
    v_mov_b32 v73, s34
    v_lshlrev_b32 v74, 3, v0
    s_mov_b64 exec, 65535
    buffer_store_dwordx2 v[72:73], v74, s[40:43], s56 offen

    s_mov_b64 exec, -1
L_xp13:
    s_mov_b32 s94, 0
L_fgather:
    s_lshl_b32 s56, s32, 11
    s_add_u32 s56, s56, 24576
    v_lshlrev_b32 v7, 4, v0
    v_lshlrev_b32 v11, 3, v0
    v_add_u32 v12, 512, v11
    v_mov_b32 v1, 0

    s_movk_i32 s35, 20000
L_pq14:
    s_cmp_eq_u32 s94, 1
    s_cbranch_scc1 L_pq14a
    buffer_load_dwordx2 v[72:73], v8, s[40:43], s69 offen sc1

    buffer_load_dwordx4 v[64:67], v7, s[40:43], s56 offen sc1
    buffer_load_dwordx4 v[68:71], v7, s[40:43], s56 offen offset:1024 sc1

    s_waitcnt vmcnt(2)
    s_getreg_b32 s94, hwreg(HW_REG_XCC_ID, 0, 4)
    v_xor_b32 v73, s34, v73
    v_bitop3_b32 v72, v72, v73, s94 bitop3:0xde
    v_cmp_ne_u32 vcc, 0, v72
    s_and_b32 s94, vcc_lo, 0x0fffffff
    s_cselect_b32 s94, 0, 1

    s_branch L_pq14b
L_pq14a:

    buffer_load_dwordx4 v[64:67], v7, s[40:43], s56 offen sc1
    buffer_load_dwordx4 v[68:71], v7, s[40:43], s56 offen offset:1024 sc1

L_pq14b:
    s_waitcnt vmcnt(0)
    v_bitop3_b32 v13, v65, v67, s34 bitop3:0x7e
    v_bitop3_b32 v14, v69, v71, s34 bitop3:0x7e
    v_or_b32 v13, v13, v14
    v_cmp_ne_u32 vcc, 0, v13

    s_cbranch_vccz L_pq14_ok

    s_sub_u32 s35, s35, 1
    s_cbranch_scc0 L_pq14
L_pq14_ok:

    v_mov_b32 v2, s94
    ds_write2_b32 v11, v64, v66 offset0:0 offset1:1
    ds_write2_b32 v12, v68, v70 offset0:0 offset1:1
    ds_write_b32 v1, v2 offset:1188

    s_cmp_ge_u32 s33, 14
    s_cbranch_scc1 L_fwo
    s_setprio 0

    v_and_b32 v1, 1, v0
    v_lshlrev_b32 v1, 4, v1
    v_lshlrev_b32 v2, 4, v0
    s_lshl_b32 s67, s32, 12
    s_lshl_b32 s68, s33, 7
    s_add_u32 s67, s67, s68
    s_add_u32 s67, s67, 229376

    s_movk_i32 s35, 20000
L_sl15:
    ds_read_b128 v[68:71], v1 offset:1056
    ds_read_b128 v[64:67], v1 offset:1024
    s_waitcnt lgkmcnt(1)
    v_or3_b32 v12, v68, v69, v70
    v_or_b32 v12, v12, v71
    v_cmp_gt_i32 vcc, 0, v12

    s_cbranch_vccz L_sl15_ok
    s_sub_u32 s35, s35, 1
    s_cbranch_scc0 L_sl15
L_sl15_ok:

    s_cmp_eq_u32 s94, 1
    s_mov_b32 s68, 1035512379
    s_waitcnt lgkmcnt(0)
    v_max3_f32 v12, v64, v65, v66
    v_max_f32 v12, v12, v67
    v_sub_f32 v64, v64, v12
    v_sub_f32 v65, v65, v12
    v_sub_f32 v66, v66, v12
    v_sub_f32 v67, v67, v12
    v_pk_mul_f32 v[64:65], v[64:65], s[68:69] op_sel_hi:[1,0]
    v_pk_mul_f32 v[66:67], v[66:67], s[68:69] op_sel_hi:[1,0]
    v_exp_f32 v64, v64
    v_exp_f32 v65, v65
    v_exp_f32 v66, v66
    v_exp_f32 v67, v67
    v_pk_mul_f32 v[68:69], v[68:69], v[64:65]
    v_mov_b32 v64, v12
    v_pk_fma_f32 v[68:69], v[70:71], v[66:67], v[68:69]
    v_mov_b32 v65, s34
    v_mov_b32 v67, s34
    v_add_f32 v66, v68, v69
    s_mov_b64 exec, 255

    s_cbranch_scc1 L_st16p
    buffer_store_dwordx4 v[64:67], v2, s[40:43], s67 offen sc1
    s_branch L_st16e
L_st16p:
    buffer_store_dwordx4 v[64:67], v2, s[40:43], s67 offen
L_st16e:

    s_mov_b64 exec, -1
    s_branch L_fend
L_fwo:
    s_setprio 0
    s_cmp_ge_u32 s33, 21
    s_cselect_b32 s57, 1, 0
    s_mul_i32 s58, s57, 7
    s_sub_u32 s58, s33, s58
    s_sub_u32 s58, s58, 14
    s_lshl_b32 s59, s32, 1
    s_add_u32 s59, s59, s57
    s_lshl_b32 s60, s59, 2
    s_add_u32 s60, s60, s3
    s_mul_i32 s60, s60, 57344
    s_lshl_b32 s61, s58, 7
    s_add_u32 s64, s60, s61
    s_mov_b64 s[48:49], s[12:13]
    s_mov_b32 s50, 3670016
    s_mov_b32 s51, 0x20000

    s_mul_i32 s95, s3, 24576
    s_add_u32 s95, s95, 12544
    v_lshrrev_b32 v1, 5, v0
    v_lshlrev_b32 v1, 1, v1
    v_and_b32 v2, 7, v0
    v_xor_b32 v1, v1, v2
    v_lshlrev_b32 v1, 4, v1
    v_lshrrev_b32 v2, 3, v0
    s_movk_i32 s61, 896
    v_mad_u32_u24 v28, v2, s61, v1
    v_xor_b32 v29, 64, v28

    v_bfe_u32 v1, v0, 2, 2
    v_lshrrev_b32 v16, 5, v0
    v_lshl_or_b32 v16, v1, 2, v16
    v_and_b32 v17, 16, v0
    v_lshl_or_b32 v16, v17, 1, v16
    v_lshlrev_b32 v16, 7, v16
    v_lshl_or_b32 v16, v1, 5, v16
    v_and_b32 v1, 3, v0
    v_lshl_or_b32 v16, v1, 3, v16
    v_add_u32 v16, s95, v16
    v_xor_b32 v17, 32, v16
    v_xor_b32 v18, 64, v16
    v_xor_b32 v19, 0x60, v16

    v_bfe_i32 v31, v0, 2, 1
    v_and_b32 v31, 0xaaaa, v31
    v_or_b32 v31, 0x4444, v31

    v_mov_b32 v108, 0
    v_mov_b32 v112, 0
    v_mov_b32 v116, 0
    v_mov_b32 v120, 0
    s_sub_u32 s44, 0, s36
    s_subb_u32 s45, 0, s37
    s_sub_u32 s46, 0, s38
    s_subb_u32 s47, 0, s39
    s_mov_b32 s24, 0xffff0000
    s_mov_b32 s25, 0xffff0000
    s_mov_b32 s26, 0
    s_mov_b32 s27, -1

    s_lshl_b32 s61, s3, 8
    v_lshlrev_b32 v3, 2, v0
    v_add_u32 v11, s61, v3
    v_and_b32 v1, 3, v0
    v_lshlrev_b32 v1, 3, v1
    v_bfe_u32 v10, s34, v1, 8
    v_mov_b32 v9, 0xffffff00
    s_mul_i32 s65, s59, 1792
    s_lshl_b32 s61, s58, 8
    s_add_u32 s65, s65, s61
    s_add_u32 s65, s65, 114688
    v_and_b32 v1, 15, v0
    v_lshrrev_b32 v2, 4, v0
    v_lshlrev_b32 v7, 4, v1
    v_lshl_or_b32 v7, v2, 10, v7
    v_cmp_gt_u32 s[52:53], 7, v1
    v_min_u32 v1, 6, v1
    v_lshl_add_u32 v1, v1, 2, v2
    v_lshlrev_b32 v6, 7, v1
    s_lshl_b32 s66, s32, 12
    s_lshl_b32 s61, s57, 4
    s_add_u32 s66, s66, s61
    s_add_u32 s66, s66, 229376
    s_lshl_b32 s61, s57, 1
    s_lshr_b32 s63, s3, 1
    s_add_u32 s61, s61, s63
    s_lshl_b32 s61, s61, 2
    v_mov_b32 v8, s61
    s_lshl_b32 s61, s3, 2
    v_mov_b32 v4, s61
    s_lshl_b32 s67, s59, 15
    s_lshl_b32 s61, s3, 8
    s_add_u32 s67, s67, s61
    s_add_u32 s56, s67, 262144
    s_add_u32 s57, s56, 4096
    s_add_u32 s58, s56, 8192
    s_add_u32 s59, s56, 12288
    s_add_u32 s60, s56, 16384
    s_add_u32 s61, s56, 20480
    s_add_u32 s62, s56, 24576
    s_mov_b32 s63, 1035512379
    s_movk_i32 s54, 0xff

    s_cmp_eq_u32 s3, 0
    s_cbranch_scc0 L_fpoll

    v_and_b32 v1, 1, v0
    v_lshlrev_b32 v1, 4, v1
    v_lshlrev_b32 v2, 4, v0
    s_lshl_b32 s67, s32, 12
    s_lshl_b32 s68, s33, 7
    s_add_u32 s67, s67, s68
    s_add_u32 s67, s67, 229376

    s_movk_i32 s35, 20000
L_sl17:
    ds_read_b128 v[68:71], v1 offset:1056
    ds_read_b128 v[64:67], v1 offset:1024
    s_waitcnt lgkmcnt(1)
    v_or3_b32 v12, v68, v69, v70
    v_or_b32 v12, v12, v71
    v_cmp_gt_i32 vcc, 0, v12

    s_cbranch_vccz L_sl17_ok
    s_sub_u32 s35, s35, 1
    s_cbranch_scc0 L_sl17
L_sl17_ok:

    s_cmp_eq_u32 s94, 1
    s_mov_b32 s68, 1035512379
    s_waitcnt lgkmcnt(0)
    v_max3_f32 v12, v64, v65, v66
    v_max_f32 v12, v12, v67
    v_sub_f32 v64, v64, v12
    v_sub_f32 v65, v65, v12
    v_sub_f32 v66, v66, v12
    v_sub_f32 v67, v67, v12
    v_pk_mul_f32 v[64:65], v[64:65], s[68:69] op_sel_hi:[1,0]
    v_pk_mul_f32 v[66:67], v[66:67], s[68:69] op_sel_hi:[1,0]
    v_exp_f32 v64, v64
    v_exp_f32 v65, v65
    v_exp_f32 v66, v66
    v_exp_f32 v67, v67
    v_pk_mul_f32 v[68:69], v[68:69], v[64:65]
    v_mov_b32 v64, v12
    v_pk_fma_f32 v[68:69], v[70:71], v[66:67], v[68:69]
    v_mov_b32 v65, s34
    v_mov_b32 v67, s34
    v_add_f32 v66, v68, v69
    s_mov_b64 exec, 255

    s_cbranch_scc1 L_st18p
    buffer_store_dwordx4 v[64:67], v2, s[40:43], s67 offen sc1
    s_branch L_st18e
L_st18p:
    buffer_store_dwordx4 v[64:67], v2, s[40:43], s67 offen
L_st18e:

    s_mov_b64 exec, -1
L_fpoll:
    v_mov_b32 v1, 1184
    v_mov_b32 v2, 1
    s_mov_b32 m0, s95

    s_movk_i32 s35, 20000
L_si19:
    ds_read_b128 v[12:15], v2 offset:1087
    s_waitcnt lgkmcnt(0)
    v_or3_b32 v12, v12, v13, v14
    v_or_b32 v12, v12, v15
    v_cmp_ne_u32 vcc, 0, v12

    s_cbranch_vccz L_si19_ok
    s_sub_u32 s35, s35, 1
    s_cbranch_scc0 L_si19
L_si19_ok:

    buffer_load_dwordx4 v28, s[48:51], s64 offen nt lds
    s_add_u32 m0, m0, 1024
    s_add_u32 s64, s64, 7168
    buffer_load_dwordx4 v29, s[48:51], s64 offen nt lds
    s_add_u32 m0, m0, 1024
    s_add_u32 s64, s64, 7168
    buffer_load_dwordx4 v28, s[48:51], s64 offen nt lds
    s_add_u32 m0, m0, 1024
    s_add_u32 s64, s64, 7168
    buffer_load_dwordx4 v29, s[48:51], s64 offen nt lds
    s_add_u32 m0, m0, 1024
    s_add_u32 s64, s64, 7168
    buffer_load_dwordx4 v28, s[48:51], s64 offen nt lds
    s_add_u32 m0, m0, 1024
    s_add_u32 s64, s64, 7168
    buffer_load_dwordx4 v29, s[48:51], s64 offen nt lds
    s_add_u32 m0, m0, 1024
    s_add_u32 s64, s64, 7168
    buffer_load_dwordx4 v28, s[48:51], s64 offen nt lds
    s_add_u32 m0, m0, 1024
    s_add_u32 s64, s64, 7168
    buffer_load_dwordx4 v29, s[48:51], s64 offen nt lds
    s_movk_i32 s35, 20000
L_ss20:
    ds_read_b32 v12, v8 offset:1152
    s_waitcnt lgkmcnt(0)
    v_cmp_ne_u32 vcc, 0, v12

    s_cbranch_vccz L_ss20_ok
    s_sub_u32 s35, s35, 1
    s_cbranch_scc0 L_ss20
L_ss20_ok:

    s_waitcnt vmcnt(0)
    buffer_load_dwordx4 v[64:67], v6, s[40:43], s66 offen sc1
    buffer_load_dwordx4 v[68:71], v7, s[40:43], s56 offen sc1
    buffer_load_dwordx4 v[72:75], v7, s[40:43], s57 offen sc1
    buffer_load_dwordx4 v[76:79], v7, s[40:43], s58 offen sc1
    buffer_load_dwordx4 v[80:83], v7, s[40:43], s59 offen sc1
    buffer_load_dwordx4 v[84:87], v7, s[40:43], s60 offen sc1
    buffer_load_dwordx4 v[88:91], v7, s[40:43], s61 offen sc1
    buffer_load_dwordx4 v[92:95], v7, s[40:43], s62 offen sc1
    s_setprio 3
    ds_read_b64_tr_b16 v[32:33], v16 offset:0
    ds_read_b64_tr_b16 v[34:35], v16 offset:2048
    ds_read_b64_tr_b16 v[40:41], v17 offset:0
    ds_read_b64_tr_b16 v[42:43], v17 offset:2048
    ds_read_b64_tr_b16 v[48:49], v18 offset:0
    ds_read_b64_tr_b16 v[50:51], v18 offset:2048
    ds_read_b64_tr_b16 v[56:57], v19 offset:0
    ds_read_b64_tr_b16 v[58:59], v19 offset:2048
    s_waitcnt lgkmcnt(4)
    ds_read_b64_tr_b16 v[36:37], v16 offset:256
    ds_read_b64_tr_b16 v[38:39], v16 offset:2304
    ds_read_b64_tr_b16 v[44:45], v17 offset:256
    ds_read_b64_tr_b16 v[46:47], v17 offset:2304
    ds_read_b64_tr_b16 v[52:53], v18 offset:256
    ds_read_b64_tr_b16 v[54:55], v18 offset:2304
    ds_read_b64_tr_b16 v[60:61], v19 offset:256
    ds_read_b64_tr_b16 v[62:63], v19 offset:2304
    s_waitcnt vmcnt(7)
    v_bitop3_b32 v12, v65, v67, s34 bitop3:0x7e
    v_cmp_ne_u32 s[22:23], 0, v12

    s_cmp_eq_u64 s[22:23], 0
    s_cbranch_scc0 L_rbm
    s_call_b64 s[96:97], L_scale
L_rbm:
    s_mov_b64 s[18:19], s[22:23]

    s_waitcnt vmcnt(6)
    v_lshl_add_u64 v[68:69], v[68:69], 0, s[44:45]
    v_lshl_add_u64 v[70:71], v[70:71], 0, s[46:47]
    v_or3_b32 v12, v68, v69, v70
    v_bitop3_b32 v12, v12, v71, s54 bitop3:0xa8
    v_cmp_ne_u32 s[4:5], 0, v12

    s_or_b64 s[18:19], s[18:19], s[4:5]
    s_waitcnt vmcnt(5)
    v_lshl_add_u64 v[72:73], v[72:73], 0, s[44:45]
    v_lshl_add_u64 v[74:75], v[74:75], 0, s[46:47]
    v_or3_b32 v12, v72, v73, v74
    v_bitop3_b32 v12, v12, v75, s54 bitop3:0xa8
    v_cmp_ne_u32 s[6:7], 0, v12

    s_or_b64 s[18:19], s[18:19], s[6:7]
    s_waitcnt vmcnt(4)
    v_lshl_add_u64 v[76:77], v[76:77], 0, s[44:45]
    v_lshl_add_u64 v[78:79], v[78:79], 0, s[46:47]
    v_or3_b32 v12, v76, v77, v78
    v_bitop3_b32 v12, v12, v79, s54 bitop3:0xa8
    v_cmp_ne_u32 s[8:9], 0, v12

    s_or_b64 s[18:19], s[18:19], s[8:9]
    s_waitcnt vmcnt(3)
    v_lshl_add_u64 v[80:81], v[80:81], 0, s[44:45]
    v_lshl_add_u64 v[82:83], v[82:83], 0, s[46:47]
    v_or3_b32 v12, v80, v81, v82
    v_bitop3_b32 v12, v12, v83, s54 bitop3:0xa8
    v_cmp_ne_u32 s[10:11], 0, v12

    s_or_b64 s[18:19], s[18:19], s[10:11]
    s_waitcnt vmcnt(2)
    v_lshl_add_u64 v[84:85], v[84:85], 0, s[44:45]
    v_lshl_add_u64 v[86:87], v[86:87], 0, s[46:47]
    v_or3_b32 v12, v84, v85, v86
    v_bitop3_b32 v12, v12, v87, s54 bitop3:0xa8
    v_cmp_ne_u32 s[12:13], 0, v12

    s_or_b64 s[18:19], s[18:19], s[12:13]
    s_waitcnt vmcnt(1)
    v_lshl_add_u64 v[88:89], v[88:89], 0, s[44:45]
    v_lshl_add_u64 v[90:91], v[90:91], 0, s[46:47]
    v_or3_b32 v12, v88, v89, v90
    v_bitop3_b32 v12, v12, v91, s54 bitop3:0xa8
    v_cmp_ne_u32 s[14:15], 0, v12

    s_or_b64 s[18:19], s[18:19], s[14:15]
    s_waitcnt vmcnt(0)
    v_lshl_add_u64 v[92:93], v[92:93], 0, s[44:45]
    v_lshl_add_u64 v[94:95], v[94:95], 0, s[46:47]
    v_or3_b32 v12, v92, v93, v94
    v_bitop3_b32 v12, v12, v95, s54 bitop3:0xa8
    v_cmp_ne_u32 s[16:17], 0, v12

    s_or_b64 s[18:19], s[18:19], s[16:17]
    s_cbranch_scc0 L_po_ok
    s_and_b64 exec, s[22:23], -1
    s_cbranch_scc0 L_polm
    buffer_load_dwordx4 v[64:67], v6, s[40:43], s66 offen sc1
L_polm:

    s_and_b64 exec, s[4:5], -1
    s_cbranch_scc0 L_pol0
    buffer_load_dwordx4 v[68:71], v7, s[40:43], s56 offen sc1
L_pol0:

    s_and_b64 exec, s[6:7], -1
    s_cbranch_scc0 L_pol1
    buffer_load_dwordx4 v[72:75], v7, s[40:43], s57 offen sc1
L_pol1:

    s_and_b64 exec, s[8:9], -1
    s_cbranch_scc0 L_pol2
    buffer_load_dwordx4 v[76:79], v7, s[40:43], s58 offen sc1
L_pol2:

    s_and_b64 exec, s[10:11], -1
    s_cbranch_scc0 L_pol3
    buffer_load_dwordx4 v[80:83], v7, s[40:43], s59 offen sc1
L_pol3:

    s_and_b64 exec, s[12:13], -1
    s_cbranch_scc0 L_pol4
    buffer_load_dwordx4 v[84:87], v7, s[40:43], s60 offen sc1
L_pol4:

    s_and_b64 exec, s[14:15], -1
    s_cbranch_scc0 L_pol5
    buffer_load_dwordx4 v[88:91], v7, s[40:43], s61 offen sc1
L_pol5:

    s_and_b64 exec, s[16:17], -1
    s_cbranch_scc0 L_pol6
    buffer_load_dwordx4 v[92:95], v7, s[40:43], s62 offen sc1
L_pol6:

    s_movk_i32 s35, 20000
L_po:
    s_and_b64 exec, s[22:23], -1
    s_cselect_b32 s55, 1, 0
    s_waitcnt vmcnt(0)
    s_cbranch_scc0 L_pocm

    v_bitop3_b32 v12, v65, v67, s34 bitop3:0x7e
    v_cmp_ne_u32 s[22:23], 0, v12

    s_and_b64 exec, s[22:23], -1
    s_cbranch_scc0 L_pocm
    buffer_load_dwordx4 v[64:67], v6, s[40:43], s66 offen sc1
    s_mov_b32 s55, 0
L_pocm:
    s_mov_b64 s[18:19], s[22:23]

    s_and_b64 exec, s[4:5], -1
    s_cbranch_scc0 L_poc0

    v_lshl_add_u64 v[68:69], v[68:69], 0, s[44:45]
    v_lshl_add_u64 v[70:71], v[70:71], 0, s[46:47]
    v_or3_b32 v12, v68, v69, v70
    v_bitop3_b32 v12, v12, v71, s54 bitop3:0xa8
    v_cmp_ne_u32 s[4:5], 0, v12

    s_and_b64 exec, s[4:5], -1
    s_cbranch_scc0 L_poc0
    buffer_load_dwordx4 v[68:71], v7, s[40:43], s56 offen sc1
    s_mov_b64 s[18:19], -1
L_poc0:

    s_and_b64 exec, s[6:7], -1
    s_cbranch_scc0 L_poc1

    v_lshl_add_u64 v[72:73], v[72:73], 0, s[44:45]
    v_lshl_add_u64 v[74:75], v[74:75], 0, s[46:47]
    v_or3_b32 v12, v72, v73, v74
    v_bitop3_b32 v12, v12, v75, s54 bitop3:0xa8
    v_cmp_ne_u32 s[6:7], 0, v12

    s_and_b64 exec, s[6:7], -1
    s_cbranch_scc0 L_poc1
    buffer_load_dwordx4 v[72:75], v7, s[40:43], s57 offen sc1
    s_mov_b64 s[18:19], -1
L_poc1:

    s_and_b64 exec, s[8:9], -1
    s_cbranch_scc0 L_poc2

    v_lshl_add_u64 v[76:77], v[76:77], 0, s[44:45]
    v_lshl_add_u64 v[78:79], v[78:79], 0, s[46:47]
    v_or3_b32 v12, v76, v77, v78
    v_bitop3_b32 v12, v12, v79, s54 bitop3:0xa8
    v_cmp_ne_u32 s[8:9], 0, v12

    s_and_b64 exec, s[8:9], -1
    s_cbranch_scc0 L_poc2
    buffer_load_dwordx4 v[76:79], v7, s[40:43], s58 offen sc1
    s_mov_b64 s[18:19], -1
L_poc2:

    s_and_b64 exec, s[10:11], -1
    s_cbranch_scc0 L_poc3

    v_lshl_add_u64 v[80:81], v[80:81], 0, s[44:45]
    v_lshl_add_u64 v[82:83], v[82:83], 0, s[46:47]
    v_or3_b32 v12, v80, v81, v82
    v_bitop3_b32 v12, v12, v83, s54 bitop3:0xa8
    v_cmp_ne_u32 s[10:11], 0, v12

    s_and_b64 exec, s[10:11], -1
    s_cbranch_scc0 L_poc3
    buffer_load_dwordx4 v[80:83], v7, s[40:43], s59 offen sc1
    s_mov_b64 s[18:19], -1
L_poc3:

    s_and_b64 exec, s[12:13], -1
    s_cbranch_scc0 L_poc4

    v_lshl_add_u64 v[84:85], v[84:85], 0, s[44:45]
    v_lshl_add_u64 v[86:87], v[86:87], 0, s[46:47]
    v_or3_b32 v12, v84, v85, v86
    v_bitop3_b32 v12, v12, v87, s54 bitop3:0xa8
    v_cmp_ne_u32 s[12:13], 0, v12

    s_and_b64 exec, s[12:13], -1
    s_cbranch_scc0 L_poc4
    buffer_load_dwordx4 v[84:87], v7, s[40:43], s60 offen sc1
    s_mov_b64 s[18:19], -1
L_poc4:

    s_and_b64 exec, s[14:15], -1
    s_cbranch_scc0 L_poc5

    v_lshl_add_u64 v[88:89], v[88:89], 0, s[44:45]
    v_lshl_add_u64 v[90:91], v[90:91], 0, s[46:47]
    v_or3_b32 v12, v88, v89, v90
    v_bitop3_b32 v12, v12, v91, s54 bitop3:0xa8
    v_cmp_ne_u32 s[14:15], 0, v12

    s_and_b64 exec, s[14:15], -1
    s_cbranch_scc0 L_poc5
    buffer_load_dwordx4 v[88:91], v7, s[40:43], s61 offen sc1
    s_mov_b64 s[18:19], -1
L_poc5:

    s_and_b64 exec, s[16:17], -1
    s_cbranch_scc0 L_poc6

    v_lshl_add_u64 v[92:93], v[92:93], 0, s[44:45]
    v_lshl_add_u64 v[94:95], v[94:95], 0, s[46:47]
    v_or3_b32 v12, v92, v93, v94
    v_bitop3_b32 v12, v12, v95, s54 bitop3:0xa8
    v_cmp_ne_u32 s[16:17], 0, v12

    s_and_b64 exec, s[16:17], -1
    s_cbranch_scc0 L_poc6
    buffer_load_dwordx4 v[92:95], v7, s[40:43], s62 offen sc1
    s_mov_b64 s[18:19], -1
L_poc6:

    s_cmp_eq_u32 s55, 0
    s_mov_b64 exec, -1
    s_cbranch_scc1 L_pocs
    s_call_b64 s[96:97], L_scale
L_pocs:

    s_cmp_eq_u64 s[18:19], 0
    s_cbranch_scc1 L_po_ok
    s_sub_u32 s35, s35, 1
    s_cbranch_scc0 L_po
    s_waitcnt vmcnt(0)
L_po_ok:

    v_pk_mul_f32 v[96:97], v[68:69], v[124:125] op_sel_hi:[1,0]
    v_pk_mul_f32 v[98:99], v[70:71], v[124:125] op_sel_hi:[1,0]
    v_pk_fma_f32 v[96:97], v[72:73], v[126:127], v[96:97] op_sel_hi:[1,0,1]
    v_pk_fma_f32 v[98:99], v[74:75], v[126:127], v[98:99] op_sel_hi:[1,0,1]
    v_pk_fma_f32 v[96:97], v[76:77], v[128:129], v[96:97] op_sel_hi:[1,0,1]
    v_pk_fma_f32 v[98:99], v[78:79], v[128:129], v[98:99] op_sel_hi:[1,0,1]
    v_pk_fma_f32 v[96:97], v[80:81], v[130:131], v[96:97] op_sel_hi:[1,0,1]
    v_pk_fma_f32 v[98:99], v[82:83], v[130:131], v[98:99] op_sel_hi:[1,0,1]
    v_pk_fma_f32 v[96:97], v[84:85], v[132:133], v[96:97] op_sel_hi:[1,0,1]
    v_pk_fma_f32 v[98:99], v[86:87], v[132:133], v[98:99] op_sel_hi:[1,0,1]
    v_pk_fma_f32 v[96:97], v[88:89], v[134:135], v[96:97] op_sel_hi:[1,0,1]
    v_pk_fma_f32 v[98:99], v[90:91], v[134:135], v[98:99] op_sel_hi:[1,0,1]
    v_pk_fma_f32 v[96:97], v[92:93], v[136:137], v[96:97] op_sel_hi:[1,0,1]
    v_pk_fma_f32 v[98:99], v[94:95], v[136:137], v[98:99] op_sel_hi:[1,0,1]
    s_nop 1
    v_permlane32_swap_b32 v96, v98
    v_permlane32_swap_b32 v97, v99
    v_add_f32 v96, v96, v98
    v_add_f32 v97, v97, v99
    s_nop 1
    v_permlane16_swap_b32 v96, v97
    v_add_f32 v96, v96, v97

    s_waitcnt lgkmcnt(0)
    s_nop 0
    v_mov_b32_dpp v12, v96 quad_perm:[1,1,3,3] row_mask:0xf bank_mask:0xf
    v_cvt_pk_bf16_f32 v12, v96, v12

    s_nop 1
    v_mov_b32_dpp v20, v12 row_newbcast:0 row_mask:0xf bank_mask:5
    v_mov_b32_dpp v21, v12 row_newbcast:4 row_mask:0xf bank_mask:5
    v_mov_b32_dpp v22, v12 row_newbcast:8 row_mask:0xf bank_mask:5
    v_mov_b32_dpp v23, v12 row_newbcast:12 row_mask:0xf bank_mask:5
    v_mov_b32_dpp v20, v12 row_newbcast:2 row_mask:0xf bank_mask:10
    v_mov_b32_dpp v21, v12 row_newbcast:6 row_mask:0xf bank_mask:10
    v_mov_b32_dpp v22, v12 row_newbcast:10 row_mask:0xf bank_mask:10
    v_mov_b32_dpp v23, v12 row_newbcast:14 row_mask:0xf bank_mask:10
    s_nop 1
    v_smfmac_f32_16x16x64_bf16 v[108:111], v[20:23], v[32:39], v31
    v_smfmac_f32_16x16x64_bf16 v[116:119], v[20:23], v[48:55], v31
    v_smfmac_f32_16x16x64_bf16 v[112:115], v[20:23], v[40:47], v31
    v_smfmac_f32_16x16x64_bf16 v[120:123], v[20:23], v[56:63], v31
    s_nop 5
    v_cndmask_b32 v108, v108, v116, s[26:27]
    s_nop 0
    v_cndmask_b32 v112, v112, v120, s[26:27]

    s_nop 1
    v_permlane16_swap_b32 v108, v112
    v_add_f32 v108, v108, v112
    ds_write_b32 v11, v108 offset:1280
    s_mov_b64 exec, 1
    ds_add_rtn_u32 v12, v1, v2
    s_mov_b64 exec, -1
    s_waitcnt lgkmcnt(0)
    v_readfirstlane_b32 s56, v12
    s_cmp_eq_u32 s56, 2
    s_cbranch_scc0 L_fend
    ds_read2st64_b32 v[64:65], v3 offset0:5 offset1:6
    ds_read2st64_b32 v[66:67], v3 offset0:7 offset1:8
    s_waitcnt lgkmcnt(0)
    v_pk_add_f32 v[64:65], v[64:65], v[66:67]
    v_add_f32 v64, v64, v65
    v_and_or_b32 v64, v64, v9, v10
    buffer_store_dword v64, v3, s[40:43], s65 offen sc1

L_fend:

    s_endpgm
L_scale:
    v_max_f32_dpp v13, v64, v64 row_ror:8 row_mask:0xf bank_mask:0xf
    s_nop 1
    v_max_f32_dpp v13, v13, v13 row_ror:4 row_mask:0xf bank_mask:0xf
    s_nop 1
    v_max_f32_dpp v13, v13, v13 row_ror:2 row_mask:0xf bank_mask:0xf
    s_nop 1
    v_max_f32_dpp v13, v13, v13 row_ror:1 row_mask:0xf bank_mask:0xf
    v_mov_b32 v14, v13
    s_nop 1
    v_permlane16_swap_b32 v13, v14
    v_max_f32 v13, v13, v14
    v_mov_b32 v14, v13
    s_nop 1
    v_permlane32_swap_b32 v13, v14
    v_max_f32 v13, v13, v14
    v_sub_f32 v13, v64, v13
    v_mul_f32 v13, s63, v13
    v_exp_f32 v13, v13
    s_nop 0
    v_mul_f32 v14, v13, v66
    v_cndmask_b32 v14, 0, v14, s[52:53]
    s_nop 1
    v_add_f32_dpp v14, v14, v14 row_ror:4 row_mask:0xf bank_mask:0xf
    s_nop 1
    v_add_f32_dpp v14, v14, v14 row_ror:2 row_mask:0xf bank_mask:0xf
    s_nop 1
    v_add_f32_dpp v14, v14, v14 row_ror:1 row_mask:0xf bank_mask:0xf
    s_nop 1
    v_add_f32_dpp v14, v14, v14 row_ror:8 row_mask:0xf bank_mask:0xf
    v_mov_b32 v15, v14
    s_nop 1
    v_permlane16_swap_b32 v14, v15
    v_add_f32 v14, v14, v15
    v_mov_b32 v15, v14
    s_nop 1
    v_permlane32_swap_b32 v14, v15
    v_add_f32 v14, v14, v15
    v_rcp_f32 v14, v14
    s_nop 0
    v_mul_f32 v13, v13, v14

    s_nop 1
    v_mov_b32_dpp v124, v13 row_newbcast:0 row_mask:0xf bank_mask:0xf
    v_mov_b32_dpp v126, v13 row_newbcast:1 row_mask:0xf bank_mask:0xf
    v_mov_b32_dpp v128, v13 row_newbcast:2 row_mask:0xf bank_mask:0xf
    v_mov_b32_dpp v130, v13 row_newbcast:3 row_mask:0xf bank_mask:0xf
    v_mov_b32_dpp v132, v13 row_newbcast:4 row_mask:0xf bank_mask:0xf
    v_mov_b32_dpp v134, v13 row_newbcast:5 row_mask:0xf bank_mask:0xf
    v_mov_b32_dpp v136, v13 row_newbcast:6 row_mask:0xf bank_mask:0xf
    s_setpc_b64 s[96:97]
L_svc2:

    s_load_dword s34, s[30:31], 0
    s_mov_b32 s33, s2
    v_and_b32 v4, 15, v0
    v_lshrrev_b32 v5, 4, v0
    v_lshl_add_u32 v4, v4, 2, v5
    s_lshl_b32 s59, s3, 6
    v_add_u32 v4, s59, v4
    v_lshlrev_b32 v5, 1, v4

    buffer_load_ushort v7, v5, s[44:47], 0 offen
    s_mov_b64 s[44:45], s[4:5]
    buffer_load_ushort v8, v5, s[44:47], 0 offen
    s_mov_b32 s58, 3216550459
    s_mov_b32 s59, 2997186656
    s_mov_b32 s60, 1060205080
    s_mov_b32 s61, 0x42fc0000

    s_mov_b64 s[56:57], 0xffff
    v_lshlrev_b32 v1, 4, v0
    v_lshlrev_b64 v[16:17], v1, s[56:57]
    v_bfe_i32 v1, v0, 2, 1
    v_and_b32 v18, v16, v1
    v_and_b32 v19, v17, v1
    v_xor_b32 v16, v16, v18
    v_xor_b32 v17, v17, v19

    v_bfe_u32 v10, v0, 3, 1
    v_lshrrev_b32 v1, 4, v0
    v_lshl_or_b32 v10, v10, 5, v1
    v_and_b32 v1, 7, v0
    v_lshlrev_b32 v1, 4, v1
    s_movk_i32 s56, 5376
    v_mad_u32_u24 v10, v10, s56, v1

    s_mul_i32 s62, s3, 344064
    s_lshl_b32 s56, s33, 7
    s_add_u32 s62, s62, s56
    s_add_u32 s62, s62, 1792
    s_mul_i32 s63, s3, 229376
    s_add_u32 s63, s63, s56
    s_mov_b32 s64, s63
    s_mul_i32 s69, s33, 57344
    s_lshl_b32 s56, s3, 7
    s_add_u32 s69, s69, s56
    s_mov_b32 s54, 1605632
    s_mov_b32 s55, 0x20000
    s_mov_b32 s98, 1605632
    s_mov_b32 s99, 0x20000
    s_lshl_b32 s95, s3, 14
    s_add_u32 s95, s95, 12288
    v_lshrrev_b32 v1, 5, v0
    v_lshlrev_b32 v1, 1, v1
    v_and_b32 v11, 7, v0
    v_xor_b32 v1, v1, v11
    v_lshlrev_b32 v1, 4, v1
    v_lshrrev_b32 v11, 3, v0
    s_movk_i32 s56, 3584
    v_mad_u32_u24 v196, v11, s56, v1
    s_movk_i32 s56, 896
    v_mad_u32_u24 v198, v11, s56, v1
    v_xor_b32 v197, 64, v196
    v_xor_b32 v199, 64, v198

    s_mov_b64 s[52:53], s[16:17]
    s_mov_b64 s[96:97], s[18:19]
    s_mov_b64 s[40:41], s[30:31]

    v_and_b32 v9, 7, v0
    v_bfe_u32 v1, v0, 4, 1
    v_lshl_or_b32 v9, v9, 1, v1
    v_bfe_u32 v1, v0, 3, 1
    v_lshl_or_b32 v9, v9, 1, v1
    v_lshrrev_b32 v1, 5, v0
    v_lshl_or_b32 v9, v9, 1, v1

    s_lshl_b32 s65, s3, 8
    v_lshl_add_u32 v9, v9, 2, s65

    s_mov_b32 s42, 1048576
    s_mov_b32 s43, 0x20000

    s_waitcnt vmcnt(6)
    v_lshlrev_b32 v6, 16, v6
    v_mul_f32 v1, s58, v6
    v_fma_f32 v2, v6, s58, -v1
    v_min_f32 v1, s61, v1
    v_fma_f32 v2, v6, s59, v2
    v_exp_f32 v1, v1
    v_mul_f32 v2, s60, v2
    v_fma_f32 v1, v1, v2, v1
    v_add_f32 v1, 1.0, v1
    v_rcp_f32 v2, v1
    s_nop 0
    v_mul_f32 v3, v6, v2
    v_fma_f32 v1, -v3, v1, v6
    v_fma_f32 v3, v1, v2, v3
    v_cvt_pk_bf16_f32 v6, v3, v3

    s_nop 1
    v_and_b32_dpp v20, v6, v16 quad_perm:[0,0,0,0] row_mask:0xf bank_mask:0xf
    v_and_b32_dpp v21, v6, v17 quad_perm:[0,0,0,0] row_mask:0xf bank_mask:0xf
    v_and_b32_dpp v22, v6, v18 quad_perm:[0,0,0,0] row_mask:0xf bank_mask:0xf
    v_and_b32_dpp v23, v6, v19 quad_perm:[0,0,0,0] row_mask:0xf bank_mask:0xf
    v_and_b32_dpp v24, v6, v16 quad_perm:[1,1,1,1] row_mask:0xf bank_mask:0xf
    v_and_b32_dpp v25, v6, v17 quad_perm:[1,1,1,1] row_mask:0xf bank_mask:0xf
    v_and_b32_dpp v26, v6, v18 quad_perm:[1,1,1,1] row_mask:0xf bank_mask:0xf
    v_and_b32_dpp v27, v6, v19 quad_perm:[1,1,1,1] row_mask:0xf bank_mask:0xf
    s_waitcnt vmcnt(5)
    v_mfma_f32_16x16x32_bf16 v[28:31], v[20:23], v[32:35], 0
    v_and_b32_dpp v20, v6, v16 quad_perm:[2,2,2,2] row_mask:0xf bank_mask:0xf
    v_and_b32_dpp v21, v6, v17 quad_perm:[2,2,2,2] row_mask:0xf bank_mask:0xf
    v_and_b32_dpp v22, v6, v18 quad_perm:[2,2,2,2] row_mask:0xf bank_mask:0xf
    v_and_b32_dpp v23, v6, v19 quad_perm:[2,2,2,2] row_mask:0xf bank_mask:0xf
    s_waitcnt vmcnt(4)
    v_mfma_f32_16x16x32_bf16 v[28:31], v[24:27], v[36:39], v[28:31]
    v_and_b32_dpp v24, v6, v16 quad_perm:[3,3,3,3] row_mask:0xf bank_mask:0xf
    v_and_b32_dpp v25, v6, v17 quad_perm:[3,3,3,3] row_mask:0xf bank_mask:0xf
    v_and_b32_dpp v26, v6, v18 quad_perm:[3,3,3,3] row_mask:0xf bank_mask:0xf
    v_and_b32_dpp v27, v6, v19 quad_perm:[3,3,3,3] row_mask:0xf bank_mask:0xf
    s_waitcnt vmcnt(3)
    v_mfma_f32_16x16x32_bf16 v[28:31], v[20:23], v[40:43], v[28:31]
    s_waitcnt vmcnt(2)
    v_mfma_f32_16x16x32_bf16 v[28:31], v[24:27], v[44:47], v[28:31]
    s_nop 7
    v_permlane32_swap_b32 v28, v29
    v_permlane32_swap_b32 v30, v31
    s_nop 0
    v_add_f32_dpp v1, v29, v28 row_ror:8 row_mask:0xf bank_mask:0x3
    s_nop 1
    v_add_f32_dpp v1, v30, v31 row_ror:8 row_mask:0xf bank_mask:0xc

    ds_write_b32 v9, v1 offset:0
    s_waitcnt lgkmcnt(0)
    s_barrier

    s_barrier
    buffer_load_dwordx4 v[48:51], v10, s[48:51], s62 offen nt
    s_add_u32 s62, s62, 21504
    buffer_load_dwordx4 v[52:55], v10, s[48:51], s62 offen nt
    s_add_u32 s62, s62, 21504
    buffer_load_dwordx4 v[56:59], v10, s[48:51], s62 offen nt
    s_add_u32 s62, s62, 21504
    buffer_load_dwordx4 v[60:63], v10, s[48:51], s62 offen nt
    s_add_u32 s62, s62, 21504
    buffer_load_dwordx4 v[64:67], v10, s[48:51], s62 offen nt
    s_add_u32 s62, s62, 21504
    buffer_load_dwordx4 v[68:71], v10, s[48:51], s62 offen nt
    s_add_u32 s62, s62, 21504
    buffer_load_dwordx4 v[72:75], v10, s[48:51], s62 offen nt
    s_add_u32 s62, s62, 21504
    buffer_load_dwordx4 v[76:79], v10, s[48:51], s62 offen nt
    s_add_u32 m0, s95, 0
    s_nop 0
    buffer_load_dwordx4 v196, s[52:55], s63 offen nt lds
    s_add_u32 m0, m0, 1024
    s_add_u32 s63, s63, 28672
    buffer_load_dwordx4 v197, s[52:55], s63 offen nt lds
    s_add_u32 m0, m0, 1024
    s_add_u32 s63, s63, 28672
    buffer_load_dwordx4 v196, s[52:55], s63 offen nt lds
    s_add_u32 m0, m0, 1024
    s_add_u32 s63, s63, 28672
    buffer_load_dwordx4 v197, s[52:55], s63 offen nt lds
    s_add_u32 m0, m0, 1024
    s_add_u32 s63, s63, 28672
    buffer_load_dwordx4 v196, s[52:55], s63 offen nt lds
    s_add_u32 m0, m0, 1024
    s_add_u32 s63, s63, 28672
    buffer_load_dwordx4 v197, s[52:55], s63 offen nt lds
    s_add_u32 m0, m0, 1024
    s_add_u32 s63, s63, 28672
    buffer_load_dwordx4 v196, s[52:55], s63 offen nt lds
    s_add_u32 m0, m0, 1024
    s_add_u32 s63, s63, 28672
    buffer_load_dwordx4 v197, s[52:55], s63 offen nt lds
    s_waitcnt vmcnt(16)
    v_lshlrev_b32 v7, 16, v7
    v_lshlrev_b32 v8, 16, v8

    v_mul_f32 v32, s58, v7
    v_fma_f32 v33, v7, s58, -v32
    v_min_f32 v32, s61, v32
    v_fma_f32 v33, v7, s59, v33
    v_exp_f32 v32, v32
    v_mul_f32 v33, s60, v33
    v_fma_f32 v32, v32, v33, v32
    v_add_f32 v32, 1.0, v32
    v_rcp_f32 v33, v32
    s_nop 0
    v_mul_f32 v34, v7, v33
    v_fma_f32 v32, -v34, v32, v7
    v_fma_f32 v34, v32, v33, v34
    v_cvt_pk_bf16_f32 v7, v34, v34

    v_mov_b32 v6, v7
    s_nop 1
    v_mov_b32_dpp v6, v7 row_shr:4 row_mask:0xf bank_mask:0xa
    v_mov_b32_dpp v7, v7 row_shl:4 row_mask:0xf bank_mask:0x5

    s_nop 0
    v_and_b32_dpp v20, v6, v16 quad_perm:[0,0,0,0] row_mask:0xf bank_mask:0xf
    v_and_b32_dpp v21, v6, v17 quad_perm:[0,0,0,0] row_mask:0xf bank_mask:0xf
    v_and_b32_dpp v22, v6, v18 quad_perm:[0,0,0,0] row_mask:0xf bank_mask:0xf
    v_and_b32_dpp v23, v6, v19 quad_perm:[0,0,0,0] row_mask:0xf bank_mask:0xf
    v_and_b32_dpp v24, v6, v16 quad_perm:[1,1,1,1] row_mask:0xf bank_mask:0xf
    v_and_b32_dpp v25, v6, v17 quad_perm:[1,1,1,1] row_mask:0xf bank_mask:0xf
    v_and_b32_dpp v26, v6, v18 quad_perm:[1,1,1,1] row_mask:0xf bank_mask:0xf
    v_and_b32_dpp v27, v6, v19 quad_perm:[1,1,1,1] row_mask:0xf bank_mask:0xf
    s_waitcnt vmcnt(8)
    v_mfma_f32_16x16x32_bf16 v[28:31], v[20:23], v[48:51], 0
    v_and_b32_dpp v20, v6, v16 quad_perm:[2,2,2,2] row_mask:0xf bank_mask:0xf
    v_and_b32_dpp v21, v6, v17 quad_perm:[2,2,2,2] row_mask:0xf bank_mask:0xf
    v_and_b32_dpp v22, v6, v18 quad_perm:[2,2,2,2] row_mask:0xf bank_mask:0xf
    v_and_b32_dpp v23, v6, v19 quad_perm:[2,2,2,2] row_mask:0xf bank_mask:0xf
    v_mfma_f32_16x16x32_bf16 v[28:31], v[24:27], v[52:55], v[28:31]
    v_and_b32_dpp v24, v6, v16 quad_perm:[3,3,3,3] row_mask:0xf bank_mask:0xf
    v_and_b32_dpp v25, v6, v17 quad_perm:[3,3,3,3] row_mask:0xf bank_mask:0xf
    v_and_b32_dpp v26, v6, v18 quad_perm:[3,3,3,3] row_mask:0xf bank_mask:0xf
    v_and_b32_dpp v27, v6, v19 quad_perm:[3,3,3,3] row_mask:0xf bank_mask:0xf
    v_mfma_f32_16x16x32_bf16 v[28:31], v[20:23], v[56:59], v[28:31]
    v_and_b32_dpp v20, v7, v16 quad_perm:[0,0,0,0] row_mask:0xf bank_mask:0xf
    v_and_b32_dpp v21, v7, v17 quad_perm:[0,0,0,0] row_mask:0xf bank_mask:0xf
    v_and_b32_dpp v22, v7, v18 quad_perm:[0,0,0,0] row_mask:0xf bank_mask:0xf
    v_and_b32_dpp v23, v7, v19 quad_perm:[0,0,0,0] row_mask:0xf bank_mask:0xf
    v_mfma_f32_16x16x32_bf16 v[28:31], v[24:27], v[60:63], v[28:31]
    v_and_b32_dpp v24, v7, v16 quad_perm:[1,1,1,1] row_mask:0xf bank_mask:0xf
    v_and_b32_dpp v25, v7, v17 quad_perm:[1,1,1,1] row_mask:0xf bank_mask:0xf
    v_and_b32_dpp v26, v7, v18 quad_perm:[1,1,1,1] row_mask:0xf bank_mask:0xf
    v_and_b32_dpp v27, v7, v19 quad_perm:[1,1,1,1] row_mask:0xf bank_mask:0xf
    v_mfma_f32_16x16x32_bf16 v[28:31], v[20:23], v[64:67], v[28:31]
    v_and_b32_dpp v20, v7, v16 quad_perm:[2,2,2,2] row_mask:0xf bank_mask:0xf
    v_and_b32_dpp v21, v7, v17 quad_perm:[2,2,2,2] row_mask:0xf bank_mask:0xf
    v_and_b32_dpp v22, v7, v18 quad_perm:[2,2,2,2] row_mask:0xf bank_mask:0xf
    v_and_b32_dpp v23, v7, v19 quad_perm:[2,2,2,2] row_mask:0xf bank_mask:0xf
    v_mfma_f32_16x16x32_bf16 v[28:31], v[24:27], v[68:71], v[28:31]
    v_and_b32_dpp v24, v7, v16 quad_perm:[3,3,3,3] row_mask:0xf bank_mask:0xf
    v_and_b32_dpp v25, v7, v17 quad_perm:[3,3,3,3] row_mask:0xf bank_mask:0xf
    v_and_b32_dpp v26, v7, v18 quad_perm:[3,3,3,3] row_mask:0xf bank_mask:0xf
    v_and_b32_dpp v27, v7, v19 quad_perm:[3,3,3,3] row_mask:0xf bank_mask:0xf
    v_mfma_f32_16x16x32_bf16 v[28:31], v[20:23], v[72:75], v[28:31]
    s_nop 0
    v_mfma_f32_16x16x32_bf16 v[28:31], v[24:27], v[76:79], v[28:31]
    s_nop 7
    v_permlane32_swap_b32 v28, v29
    v_permlane32_swap_b32 v30, v31
    s_nop 0
    v_add_f32_dpp v1, v29, v28 row_ror:8 row_mask:0xf bank_mask:0x3
    s_nop 1
    v_add_f32_dpp v1, v30, v31 row_ror:8 row_mask:0xf bank_mask:0xc

    ds_write_b32 v9, v1 offset:2048
    s_waitcnt lgkmcnt(0)
    s_barrier

    s_add_u32 m0, s95, 8192
    s_nop 0
    buffer_load_dwordx4 v196, s[96:99], s64 offen nt lds
    s_add_u32 m0, m0, 1024
    s_add_u32 s64, s64, 28672
    buffer_load_dwordx4 v197, s[96:99], s64 offen nt lds
    s_add_u32 m0, m0, 1024
    s_add_u32 s64, s64, 28672
    buffer_load_dwordx4 v196, s[96:99], s64 offen nt lds
    s_add_u32 m0, m0, 1024
    s_add_u32 s64, s64, 28672
    buffer_load_dwordx4 v197, s[96:99], s64 offen nt lds
    s_add_u32 m0, m0, 1024
    s_add_u32 s64, s64, 28672
    buffer_load_dwordx4 v196, s[96:99], s64 offen nt lds
    s_add_u32 m0, m0, 1024
    s_add_u32 s64, s64, 28672
    buffer_load_dwordx4 v197, s[96:99], s64 offen nt lds
    s_add_u32 m0, m0, 1024
    s_add_u32 s64, s64, 28672
    buffer_load_dwordx4 v196, s[96:99], s64 offen nt lds
    s_add_u32 m0, m0, 1024
    s_add_u32 s64, s64, 28672
    buffer_load_dwordx4 v197, s[96:99], s64 offen nt lds
    v_bfe_u32 v1, v0, 2, 2
    v_lshrrev_b32 v192, 5, v0
    v_lshl_or_b32 v192, v1, 2, v192
    v_and_b32 v193, 16, v0
    v_lshl_or_b32 v192, v193, 1, v192
    v_lshlrev_b32 v192, 7, v192
    v_lshl_or_b32 v192, v1, 5, v192
    v_and_b32 v1, 3, v0
    v_lshl_or_b32 v192, v1, 3, v192
    v_add_u32 v192, s95, v192
    v_xor_b32 v193, 32, v192
    v_xor_b32 v194, 64, v192
    v_xor_b32 v195, 0x60, v192

    s_waitcnt vmcnt(8)
    ds_read_b64_tr_b16 v[80:81], v192 offset:0
    ds_read_b64_tr_b16 v[82:83], v192 offset:2048
    ds_read_b64_tr_b16 v[88:89], v193 offset:0
    ds_read_b64_tr_b16 v[90:91], v193 offset:2048
    ds_read_b64_tr_b16 v[96:97], v194 offset:0
    ds_read_b64_tr_b16 v[98:99], v194 offset:2048
    ds_read_b64_tr_b16 v[104:105], v195 offset:0
    ds_read_b64_tr_b16 v[106:107], v195 offset:2048
    s_waitcnt lgkmcnt(4)
    ds_read_b64_tr_b16 v[84:85], v192 offset:256
    ds_read_b64_tr_b16 v[86:87], v192 offset:2304
    ds_read_b64_tr_b16 v[92:93], v193 offset:256
    ds_read_b64_tr_b16 v[94:95], v193 offset:2304
    ds_read_b64_tr_b16 v[100:101], v194 offset:256
    ds_read_b64_tr_b16 v[102:103], v194 offset:2304
    ds_read_b64_tr_b16 v[108:109], v195 offset:256
    ds_read_b64_tr_b16 v[110:111], v195 offset:2304
    s_waitcnt lgkmcnt(0)
    s_add_u32 m0, s95, 0
    s_mov_b64 s[44:45], s[20:21]
    s_mov_b32 s46, 1605632
    buffer_load_dwordx4 v198, s[44:47], s69 offen nt lds
    s_add_u32 m0, m0, 1024
    s_add_u32 s69, s69, 7168
    buffer_load_dwordx4 v199, s[44:47], s69 offen nt lds
    s_add_u32 m0, m0, 1024
    s_add_u32 s69, s69, 7168
    buffer_load_dwordx4 v198, s[44:47], s69 offen nt lds
    s_add_u32 m0, m0, 1024
    s_add_u32 s69, s69, 7168
    buffer_load_dwordx4 v199, s[44:47], s69 offen nt lds
    s_add_u32 m0, m0, 1024
    s_add_u32 s69, s69, 7168
    buffer_load_dwordx4 v198, s[44:47], s69 offen nt lds
    s_add_u32 m0, m0, 1024
    s_add_u32 s69, s69, 7168
    buffer_load_dwordx4 v199, s[44:47], s69 offen nt lds
    s_add_u32 m0, m0, 1024
    s_add_u32 s69, s69, 7168
    buffer_load_dwordx4 v198, s[44:47], s69 offen nt lds
    s_add_u32 m0, m0, 1024
    s_add_u32 s69, s69, 7168
    buffer_load_dwordx4 v199, s[44:47], s69 offen nt lds
    s_add_u32 s34, s34, 2654435761
    s_and_b32 s36, s34, 0xff
    s_bfe_u32 s37, s34, 0x80008
    s_bfe_u32 s38, s34, 0x80010
    s_lshr_b32 s39, s34, 24

    v_lshlrev_b32 v10, 2, v0
    v_mov_b32 v11, 0xffffff00
    v_and_b32 v1, 3, v0
    v_lshlrev_b32 v1, 3, v1
    v_bfe_u32 v12, s34, v1, 8
    v_lshlrev_b32 v2, 3, v4
    v_lshlrev_b32 v6, 2, v4
    v_and_b32 v9, 0x1ff, v2
    v_and_b32 v1, 15, v0
    v_lshlrev_b32 v1, 4, v1
    v_lshrrev_b32 v3, 4, v0
    s_movk_i32 s56, 1792
    v_mad_u32_u24 v3, v3, s56, v1
    s_lshl_b32 s56, s3, 3
    s_add_u32 s56, s56, 4096
    v_lshrrev_b32 v1, 5, v0
    v_lshl_add_u32 v1, v1, 2, s56
    v_add_u32 v5, 4608, v10
    v_and_b32 v7, 31, v0
    v_cmp_eq_u32 vcc, 31, v7
    s_nop 1
    v_cndmask_b32 v5, v5, v1, vcc
    s_lshl_b32 s56, s3, 9
    s_add_u32 s56, s56, 8192
    v_lshl_add_u32 v7, v0, 3, s56
    s_lshl_b32 s56, s3, 8
    s_add_u32 s65, s56, 114688
    s_add_u32 s66, s65, 7168
    s_add_u32 s67, s65, 14336
    s_add_u32 s68, s65, 21504
    s_mul_i32 s69, s33, 1792

    s_add_u32 s69, s69, s56
    s_add_u32 s69, s69, 147456
    s_mov_b32 s56, 98304
    s_mov_b32 s57, 105472
    s_mov_b32 s62, 991054117
    s_mov_b32 s64, 925353388

    s_sub_u32 s4, 0, s36
    s_subb_u32 s5, 0, s37
    s_sub_u32 s6, 0, s38
    s_subb_u32 s7, 0, s39
    s_mov_b32 s8, 0xffff0000
    s_mov_b32 s9, 0xffff0000
    s_mov_b32 s10, 0
    s_mov_b32 s11, -1

    v_bfe_i32 v15, v0, 2, 1
    v_and_b32 v15, 0xaaaa, v15
    v_or_b32 v15, 0x4444, v15

    v_mov_b32 v28, 0
    v_mov_b32 v29, 0
    ds_write2st64_b32 v10, v28, v28 offset0:32 offset1:33
    ds_write_b64 v28, v[28:29] offset:4096

    v_and_b32 v1, 31, v0
    v_cmp_eq_u32 vcc, 31, v1
    v_lshrrev_b32 v1, 5, v0
    v_lshlrev_b32 v1, 2, v1
    v_add_u32 v1, 4096, v1
    v_add_u32 v5, 4608, v10
    v_cndmask_b32 v29, v5, v1, vcc
    s_mov_b64 s[14:15], vcc

    s_mov_b32 s12, 1
    s_branch L_py_ok
L_dry1:
    s_mov_b32 s12, 0
    v_mov_b32 v200, 0
    v_mov_b32 v204, 0
    v_mov_b32 v208, 0
    v_mov_b32 v212, 0
    v_mov_b32 v216, 0
    v_mov_b32 v220, 0
    v_mov_b32 v224, 0
    v_mov_b32 v228, 0
    v_mov_b32 v232, 0
    v_mov_b32 v236, 0
    v_mov_b32 v240, 0
    v_mov_b32 v244, 0
    v_mov_b32 v5, v29
    s_movk_i32 s35, 20000
L_pb21:
    buffer_load_dwordx2 v[32:33], v2, s[40:43], s56 offen sc1
    buffer_load_dwordx2 v[34:35], v2, s[40:43], s56 offen offset:3584 sc1
    buffer_load_dwordx2 v[36:37], v2, s[40:43], s57 offen sc1
    s_waitcnt vmcnt(0)
    v_bitop3_b32 v1, v33, v35, s34 bitop3:0x7e
    v_xor_b32 v37, s34, v37
    v_or_b32 v1, v1, v37
    v_cmp_ne_u32 vcc, 0, v1

    s_cbranch_vccz L_pb21_ok

    s_sub_u32 s35, s35, 1
    s_cbranch_scc0 L_pb21
L_pb21_ok:

    buffer_load_dwordx4 v[176:179], v3, s[40:43], s65 offen sc1
    buffer_load_dwordx4 v[180:183], v3, s[40:43], s66 offen sc1
    buffer_load_dwordx4 v[184:187], v3, s[40:43], s67 offen sc1
    buffer_load_dwordx4 v[188:191], v3, s[40:43], s68 offen sc1
    v_add_f32 v36, 1.0, v36
    v_cvt_pk_bf16_f32 v36, 0, v36
    ds_read_b64_tr_b16 v[112:113], v192 offset:8192
    ds_read_b64_tr_b16 v[114:115], v192 offset:10240
    ds_read_b64_tr_b16 v[120:121], v193 offset:8192
    ds_read_b64_tr_b16 v[122:123], v193 offset:10240
    ds_read_b64_tr_b16 v[128:129], v194 offset:8192
    ds_read_b64_tr_b16 v[130:131], v194 offset:10240
    ds_read_b64_tr_b16 v[136:137], v195 offset:8192
    ds_read_b64_tr_b16 v[138:139], v195 offset:10240
    s_waitcnt lgkmcnt(4)
    ds_read_b64_tr_b16 v[116:117], v192 offset:8448
    ds_read_b64_tr_b16 v[118:119], v192 offset:10496
    ds_read_b64_tr_b16 v[124:125], v193 offset:8448
    ds_read_b64_tr_b16 v[126:127], v193 offset:10496
    ds_read_b64_tr_b16 v[132:133], v194 offset:8448
    ds_read_b64_tr_b16 v[134:135], v194 offset:10496
    ds_read_b64_tr_b16 v[140:141], v195 offset:8448
    ds_read_b64_tr_b16 v[142:143], v195 offset:10496
    s_waitcnt lgkmcnt(4)
    ds_read_b64_tr_b16 v[144:145], v192 offset:0
    ds_read_b64_tr_b16 v[146:147], v192 offset:2048
    ds_read_b64_tr_b16 v[152:153], v193 offset:0
    ds_read_b64_tr_b16 v[154:155], v193 offset:2048
    ds_read_b64_tr_b16 v[160:161], v194 offset:0
    ds_read_b64_tr_b16 v[162:163], v194 offset:2048
    ds_read_b64_tr_b16 v[168:169], v195 offset:0
    ds_read_b64_tr_b16 v[170:171], v195 offset:2048
    s_waitcnt lgkmcnt(4)
    ds_read_b64_tr_b16 v[148:149], v192 offset:256
    ds_read_b64_tr_b16 v[150:151], v192 offset:2304
    ds_read_b64_tr_b16 v[156:157], v193 offset:256
    ds_read_b64_tr_b16 v[158:159], v193 offset:2304
    ds_read_b64_tr_b16 v[164:165], v194 offset:256
    ds_read_b64_tr_b16 v[166:167], v194 offset:2304
    ds_read_b64_tr_b16 v[172:173], v195 offset:256
    ds_read_b64_tr_b16 v[174:175], v195 offset:2304
    s_movk_i32 s35, 20000
    s_branch L_pyc
L_py:
    buffer_load_dwordx4 v[176:179], v3, s[40:43], s65 offen sc1
    buffer_load_dwordx4 v[180:183], v3, s[40:43], s66 offen sc1
    buffer_load_dwordx4 v[184:187], v3, s[40:43], s67 offen sc1
    buffer_load_dwordx4 v[188:191], v3, s[40:43], s68 offen sc1
L_pyc:
    s_waitcnt vmcnt(3)
    v_lshl_add_u64 v[176:177], v[176:177], 0, s[4:5]
    v_lshl_add_u64 v[178:179], v[178:179], 0, s[6:7]
    v_or3_b32 v1, v176, v177, v178
    s_waitcnt vmcnt(2)
    v_lshl_add_u64 v[180:181], v[180:181], 0, s[4:5]
    v_lshl_add_u64 v[182:183], v[182:183], 0, s[6:7]
    v_or3_b32 v1, v1, v180, v181
    v_pk_add_f32 v[176:177], v[176:177], v[180:181]
    v_or3_b32 v13, v179, v182, v183
    v_pk_add_f32 v[178:179], v[178:179], v[182:183]
    s_waitcnt vmcnt(1)
    v_lshl_add_u64 v[184:185], v[184:185], 0, s[4:5]
    v_lshl_add_u64 v[186:187], v[186:187], 0, s[6:7]
    v_or3_b32 v1, v1, v184, v185
    v_pk_add_f32 v[176:177], v[176:177], v[184:185]
    v_or3_b32 v13, v13, v186, v187
    v_pk_add_f32 v[178:179], v[178:179], v[186:187]
    s_waitcnt vmcnt(0)
    v_lshl_add_u64 v[188:189], v[188:189], 0, s[4:5]
    v_lshl_add_u64 v[190:191], v[190:191], 0, s[6:7]
    v_or3_b32 v1, v1, v188, v189
    v_pk_add_f32 v[176:177], v[176:177], v[188:189]
    v_or3_b32 v13, v13, v190, v191
    v_pk_add_f32 v[178:179], v[178:179], v[190:191]
    v_bitop3_b32 v1, v1, v13, v11 bitop3:0x54
    v_cmp_ne_u32 vcc, 0, v1

    s_cbranch_vccz L_py_ok

    s_sub_u32 s35, s35, 1
    s_cbranch_scc0 L_py
L_py_ok:

    v_permlane32_swap_b32 v176, v178
    v_permlane32_swap_b32 v177, v179
    v_add_f32 v176, v176, v178
    v_add_f32 v177, v177, v179
    s_nop 1
    v_permlane16_swap_b32 v176, v177
    v_add_f32 v1, v176, v177

    v_cvt_pk_bf16_f32 v1, 0, v1
    v_mul_f32 v1, v1, v32
    v_cvt_pk_bf16_f32 v1, 0, v1
    v_add_f32 v1, v1, v8
    v_cvt_pk_bf16_f32 v14, 0, v1
    v_mul_f32 v39, v14, v14
    v_mov_b32 v38, v14
    s_nop 1
    v_permlane32_swap_b32 v38, v39
    v_add_f32 v38, v38, v39

    s_nop 1
    v_add_f32_dpp v38, v38, v38 row_shr:1 row_mask:0xf bank_mask:0xf
    s_nop 1
    v_add_f32_dpp v38, v38, v38 row_shr:2 row_mask:0xf bank_mask:0xf
    s_nop 1
    v_add_f32_dpp v38, v38, v38 row_shr:4 row_mask:0xf bank_mask:0xf
    s_nop 1
    v_add_f32_dpp v38, v38, v38 row_shr:8 row_mask:0xf bank_mask:0xf
    s_nop 1
    v_add_f32_dpp v38, v38, v38 row_bcast:15 row_mask:0xa bank_mask:0xf
    s_mov_b64 exec, s[14:15]
    ds_add_f32 v5, v38
    s_mov_b64 exec, -1
    s_waitcnt lgkmcnt(0)
    s_barrier
    ds_read_b64 v[40:41], v28 offset:4096
    s_waitcnt lgkmcnt(0)

    v_pk_mul_f32 v[42:43], v[40:41], s[62:63] op_sel_hi:[1,0]
    s_nop 0
    v_fma_f32 v43, -v42, v42, v43
    v_cvt_pk_bf16_f32 v42, 0, v42
    v_max_f32 v43, 0, v43
    v_sub_f32 v42, v14, v42
    v_cvt_pk_bf16_f32 v43, 0, v43
    v_cvt_pk_bf16_f32 v42, 0, v42
    v_add_f32 v43, s64, v43
    v_cvt_pk_bf16_f32 v43, 0, v43
    v_sqrt_f32 v43, v43
    s_nop 0
    v_cvt_pk_bf16_f32 v43, 0, v43
    v_rcp_f32 v43, v43
    s_nop 0
    v_mul_f32 v42, v42, v43

    v_cvt_pk_bf16_f32 v1, 0, v42
    v_mul_f32 v1, v1, v36
    v_cvt_pk_bf16_f32 v1, 0, v1
    v_add_f32 v1, v1, v34
    s_nop 1
    v_mov_b32_dpp v38, v1 quad_perm:[1,1,3,3] row_mask:0xf bank_mask:0xf
    v_cvt_pk_bf16_f32 v38, v1, v38

    s_nop 1
    v_mov_b32_dpp v20, v38 row_newbcast:0 row_mask:0xf bank_mask:5
    v_mov_b32_dpp v21, v38 row_newbcast:4 row_mask:0xf bank_mask:5
    v_mov_b32_dpp v22, v38 row_newbcast:8 row_mask:0xf bank_mask:5
    v_mov_b32_dpp v23, v38 row_newbcast:12 row_mask:0xf bank_mask:5
    v_mov_b32_dpp v20, v38 row_newbcast:2 row_mask:0xf bank_mask:10
    v_mov_b32_dpp v21, v38 row_newbcast:6 row_mask:0xf bank_mask:10
    v_mov_b32_dpp v22, v38 row_newbcast:10 row_mask:0xf bank_mask:10
    v_mov_b32_dpp v23, v38 row_newbcast:14 row_mask:0xf bank_mask:10
    s_nop 1
    v_smfmac_f32_16x16x64_bf16 v[200:203], v[20:23], v[80:87], v15
    v_smfmac_f32_16x16x64_bf16 v[208:211], v[20:23], v[96:103], v15
    v_smfmac_f32_16x16x64_bf16 v[204:207], v[20:23], v[88:95], v15
    v_smfmac_f32_16x16x64_bf16 v[212:215], v[20:23], v[104:111], v15
    v_smfmac_f32_16x16x64_bf16 v[216:219], v[20:23], v[112:119], v15
    v_smfmac_f32_16x16x64_bf16 v[224:227], v[20:23], v[128:135], v15
    v_smfmac_f32_16x16x64_bf16 v[220:223], v[20:23], v[120:127], v15
    v_smfmac_f32_16x16x64_bf16 v[228:231], v[20:23], v[136:143], v15
    ds_write_b32 v6, v14 offset:5120
    s_nop 0
    v_cndmask_b32 v200, v200, v208, s[10:11]
    s_nop 0
    v_cndmask_b32 v204, v204, v212, s[10:11]

    s_nop 0
    v_cndmask_b32 v216, v216, v224, s[10:11]
    s_nop 0
    v_cndmask_b32 v220, v220, v228, s[10:11]

    v_permlane16_swap_b32 v200, v204
    s_nop 0
    v_permlane16_swap_b32 v216, v220
    v_add_f32 v200, v200, v204
    v_add_f32 v216, v216, v220
    ds_write2_b32 v7, v200, v216 offset0:0 offset1:1

    s_waitcnt lgkmcnt(0)
    s_barrier

    ds_read_b64 v[40:41], v9 offset:8192
    ds_read_b64 v[42:43], v9 offset:8704
    ds_read_b64 v[44:45], v9 offset:9216
    ds_read_b64 v[46:47], v9 offset:9728
    ds_read_b64 v[48:49], v9 offset:10240
    ds_read_b64 v[50:51], v9 offset:10752
    ds_read_b64 v[52:53], v9 offset:11264
    s_waitcnt lgkmcnt(5)
    v_pk_add_f32 v[40:41], v[40:41], v[42:43]
    s_waitcnt lgkmcnt(3)
    v_pk_add_f32 v[44:45], v[44:45], v[46:47]
    s_waitcnt lgkmcnt(1)
    v_pk_add_f32 v[48:49], v[48:49], v[50:51]
    v_pk_add_f32 v[40:41], v[40:41], v[44:45]
    s_waitcnt lgkmcnt(0)
    v_pk_add_f32 v[48:49], v[48:49], v[52:53]
    v_pk_add_f32 v[40:41], v[40:41], v[48:49]

    v_cvt_pk_bf16_f32 v40, 0, v40
    v_cvt_pk_bf16_f32 v41, 0, v41
    v_mul_f32 v42, s58, v40
    v_exp_f32 v42, v42
    s_nop 0
    v_add_f32 v42, 1.0, v42
    v_rcp_f32 v42, v42
    s_nop 0
    v_mul_f32 v40, v40, v42

    v_cvt_pk_bf16_f32 v40, 0, v40
    v_mul_f32 v40, v40, v41
    s_nop 1
    v_mov_b32_dpp v38, v40 quad_perm:[1,1,3,3] row_mask:0xf bank_mask:0xf
    v_cvt_pk_bf16_f32 v38, v40, v38

    s_nop 1
    v_mov_b32_dpp v20, v38 row_newbcast:0 row_mask:0xf bank_mask:5
    v_mov_b32_dpp v21, v38 row_newbcast:4 row_mask:0xf bank_mask:5
    v_mov_b32_dpp v22, v38 row_newbcast:8 row_mask:0xf bank_mask:5
    v_mov_b32_dpp v23, v38 row_newbcast:12 row_mask:0xf bank_mask:5
    v_mov_b32_dpp v20, v38 row_newbcast:2 row_mask:0xf bank_mask:10
    v_mov_b32_dpp v21, v38 row_newbcast:6 row_mask:0xf bank_mask:10
    v_mov_b32_dpp v22, v38 row_newbcast:10 row_mask:0xf bank_mask:10
    v_mov_b32_dpp v23, v38 row_newbcast:14 row_mask:0xf bank_mask:10
    s_cmp_eq_u32 s12, 0
    s_nop 0
    v_smfmac_f32_16x16x64_bf16 v[232:235], v[20:23], v[144:151], v15
    v_smfmac_f32_16x16x64_bf16 v[240:243], v[20:23], v[160:167], v15
    v_smfmac_f32_16x16x64_bf16 v[236:239], v[20:23], v[152:159], v15
    v_smfmac_f32_16x16x64_bf16 v[244:247], v[20:23], v[168:175], v15
    s_nop 5
    v_cndmask_b32 v232, v232, v240, s[10:11]
    s_nop 0
    v_cndmask_b32 v236, v236, v244, s[10:11]

    s_nop 1
    v_permlane16_swap_b32 v232, v236
    v_add_f32 v232, v232, v236
    v_and_or_b32 v1, v232, v11, v12
    s_cbranch_scc0 L_dry1
    buffer_store_dword v1, v10, s[40:43], s69 offen sc1

    s_waitcnt vmcnt(0)
    s_barrier
    s_endpgm
L_sv7:
    s_mov_b32 s33, s2
    v_and_b32 v9, 31, v0
    v_lshlrev_b32 v10, 4, v9
    v_lshlrev_b32 v9, 3, v9
    s_lshl_b32 s65, s57, 5
    s_lshl_b32 s56, s56, 9
    s_add_u32 s65, s65, s56
    s_add_u32 s65, s65, 4096
    s_lshl_b32 s66, s33, 9
    s_add_u32 s66, s66, 98304
    s_waitcnt lgkmcnt(0)
    s_load_dword s34, s[30:31], 0
    s_mov_b64 s[40:41], s[30:31]

    s_mov_b32 s42, 1048576
    s_mov_b32 s43, 0x20000

    s_mov_b64 s[44:45], s[26:27]
    s_movk_i32 s46, 896
    s_mov_b32 s47, 0x20000
    s_waitcnt lgkmcnt(0)

    s_add_u32 s34, s34, 2654435761
    s_and_b32 s36, s34, 0xff
    s_bfe_u32 s37, s34, 0x80008
    s_bfe_u32 s38, s34, 0x80010
    s_lshr_b32 s39, s34, 24

    v_mov_b32 v21, s34
    v_mov_b32 v23, s34
    s_sub_u32 s4, 0, s36
    s_subb_u32 s5, 0, s37
    s_sub_u32 s6, 0, s38
    s_subb_u32 s7, 0, s39
    s_mov_b32 s8, 0xffff0000
    s_mov_b32 s9, 0xffff0000
    s_mov_b32 s10, 0
    s_mov_b32 s11, -1

    s_movk_i32 s13, 0xff
    s_barrier
    ds_read_b64 v[44:45], v9 offset:0
    ds_read_b64 v[46:47], v9 offset:256
    ds_read_b64 v[48:49], v9 offset:512
    ds_read_b64 v[50:51], v9 offset:768
    ds_read_b64 v[52:53], v9 offset:1024
    ds_read_b64 v[54:55], v9 offset:1280
    ds_read_b64 v[56:57], v9 offset:1536
    s_waitcnt lgkmcnt(3)
    v_pk_add_f32 v[44:45], v[44:45], v[46:47]
    v_pk_add_f32 v[48:49], v[48:49], v[50:51]
    s_waitcnt lgkmcnt(0)
    v_pk_add_f32 v[52:53], v[52:53], v[54:55]
    v_pk_add_f32 v[44:45], v[44:45], v[48:49]
    v_pk_add_f32 v[52:53], v[52:53], v[56:57]
    v_add_f32 v20, v44, v52
    v_add_f32 v22, v45, v53

    s_mov_b32 exec_hi, 0
    buffer_store_dwordx4 v[20:23], v10, s[40:43], s65 offen sc1
    s_mov_b32 exec_hi, -1

    s_barrier
    v_and_b32 v1, 3, v0
    s_lshl_b32 s56, s33, 4
    v_lshrrev_b32 v2, 4, v0
    v_lshl_add_u32 v2, v1, 2, v2
    v_add_u32 v2, s56, v2
    v_lshlrev_b32 v3, 3, v2
    v_lshlrev_b32 v4, 2, v2
    v_lshlrev_b32 v5, 1, v2
    v_lshrrev_b32 v6, 2, v0
    v_lshlrev_b32 v1, 4, v1
    s_movk_i32 s57, 1792
    v_mad_u32_u24 v6, v6, s57, v1
    s_lshl_b32 s67, s33, 6
    s_add_u32 s67, s67, 147456
    s_add_u32 s68, s67, 28672
    s_mov_b32 s69, 109056
    v_mov_b32 v36, s36
    v_mov_b32 v37, s37
    v_mov_b32 v38, s38
    v_mov_b32 v39, s39
    s_barrier

    ds_read_b64 v[44:45], v9 offset:2048
    ds_read_b64 v[46:47], v9 offset:2304
    ds_read_b64 v[48:49], v9 offset:2560
    ds_read_b64 v[50:51], v9 offset:2816
    ds_read_b64 v[52:53], v9 offset:3072
    ds_read_b64 v[54:55], v9 offset:3328
    ds_read_b64 v[56:57], v9 offset:3584
    s_waitcnt lgkmcnt(3)
    v_pk_add_f32 v[44:45], v[44:45], v[46:47]
    v_pk_add_f32 v[48:49], v[48:49], v[50:51]
    s_waitcnt lgkmcnt(0)
    v_pk_add_f32 v[52:53], v[52:53], v[54:55]
    v_pk_add_f32 v[44:45], v[44:45], v[48:49]
    v_pk_add_f32 v[52:53], v[52:53], v[56:57]
    v_add_f32 v20, v44, v52
    v_add_f32 v22, v45, v53

    v_cvt_pk_bf16_f32 v22, v20, v22
    v_lshlrev_b32 v20, 16, v22
    v_and_b32 v22, 0xffff0000, v22
    s_mov_b32 exec_hi, 0
    buffer_store_dwordx4 v[20:23], v10, s[40:43], s66 offen sc1
    s_mov_b32 exec_hi, -1

    s_barrier
    s_barrier
    s_movk_i32 s35, 20000
L_pg22:
    buffer_load_dwordx2 v[26:27], v3, s[40:43], s69 offen sc1
    s_waitcnt vmcnt(0)
    v_cmp_ne_u32 vcc, s34, v27

    s_cbranch_vccz L_pg22_ok

    s_sub_u32 s35, s35, 1
    s_cbranch_scc0 L_pg22
L_pg22_ok:

    s_mov_b32 s12, 1
    s_branch L_fin7
L_dry7:
    s_mov_b64 exec, -1
    s_mov_b32 s12, 0

    s_barrier
    s_barrier
    ds_read_b32 v24, v4 offset:5120

    s_cmp_eq_u32 s33, 0
    s_cbranch_scc0 L_s7end
    s_mov_b64 exec, 1
    v_mov_b32 v2, 0
    buffer_store_dword v21, v2, s[40:43], 0 offen sc1
    s_mov_b64 exec, -1
L_s7end:

    s_barrier
    s_movk_i32 s35, 20000
L_pf23:
    buffer_load_dwordx4 v[32:35], v6, s[40:43], s67 offen sc1
    s_mov_b32 exec_hi, 0xffff
    buffer_load_dwordx4 v[36:39], v6, s[40:43], s68 offen sc1
    s_mov_b32 exec_hi, -1
    s_waitcnt vmcnt(1)

    v_lshl_add_u64 v[32:33], v[32:33], 0, s[4:5]
    v_lshl_add_u64 v[34:35], v[34:35], 0, s[6:7]
    v_or3_b32 v1, v32, v33, v34
    s_waitcnt vmcnt(0)
    v_lshl_add_u64 v[40:41], v[36:37], 0, s[4:5]
    v_lshl_add_u64 v[42:43], v[38:39], 0, s[6:7]
    v_or3_b32 v1, v1, v35, v40
    v_or3_b32 v1, v1, v41, v42
    v_bitop3_b32 v1, v1, v43, s13 bitop3:0xa8
    v_pk_add_f32 v[32:33], v[32:33], v[40:41]
    v_cmp_ne_u32 vcc, 0, v1
    v_pk_add_f32 v[34:35], v[34:35], v[42:43]

    s_cbranch_vccz L_pf23_ok

    s_sub_u32 s35, s35, 1
    s_cbranch_scc0 L_pf23
L_pf23_ok:

L_fin7:
    s_nop 0
    v_permlane32_swap_b32 v32, v34
    v_permlane32_swap_b32 v33, v35
    v_add_f32 v32, v32, v34
    v_add_f32 v33, v33, v35
    s_nop 1
    v_permlane16_swap_b32 v32, v33
    v_add_f32 v1, v32, v33

    s_nop 1
    v_add_f32_dpp v1, v1, v1 row_ror:8 row_mask:0xf bank_mask:0xf
    s_nop 1
    v_add_f32_dpp v1, v1, v1 row_ror:4 row_mask:0xf bank_mask:0xf

    v_cvt_pk_bf16_f32 v1, 0, v1
    v_mul_f32 v1, v1, v26
    v_cvt_pk_bf16_f32 v1, 0, v1
    s_cmp_eq_u32 s12, 0
    s_waitcnt lgkmcnt(0)
    v_add_f32 v1, v1, v24
    v_cvt_pk_bf16_f32 v1, v1, v1
    s_mov_b32 exec_lo, 0x000f000f
    s_mov_b32 exec_hi, 0x000f000f
    s_cbranch_scc0 L_dry7
    buffer_store_short v1, v5, s[44:47], 0 offen

    s_endpgm
L_end:
    s_endpgm
L_code_end:

.section .rodata,"a"
.p2align 6
.amdhsa_kernel adaLN_cond__sliding_block_cached__swiglu_ffn__decode_kernel
  .amdhsa_next_free_vgpr 256
  .amdhsa_next_free_sgpr 102
  .amdhsa_accum_offset 256
  .amdhsa_group_segment_fixed_size 0
  .amdhsa_kernarg_size 112
  .amdhsa_user_sgpr_count 2
  .amdhsa_user_sgpr_kernarg_segment_ptr 1
  .amdhsa_system_sgpr_workgroup_id_x 1
  .amdhsa_float_denorm_mode_32 3
.end_amdhsa_kernel
```
